```python
import torch

def _softmax(x, axis=-1):
    return torch.softmax(x, dim=axis)

def _gelu(x):
    return torch.nn.functional.gelu(x, approximate='tanh')

def _silu(x):
    return torch.nn.functional.silu(x)

def _sigmoid(x):
    return torch.sigmoid(x)

def _layernorm(x, axis=-1, eps=1e-05):
    m = x.mean(dim=axis, keepdim=True)
    v = x.var(dim=axis, keepdim=True, unbiased=False)
    return (x - m) / torch.sqrt(v + eps)

def _scatter_add(tgt, idx, src, axis=0):
    return tgt.clone().index_add_(axis, idx, src)

def _segment_sum(src, seg, n):
    out = torch.zeros((n,) + src.shape[1:], dtype=src.dtype)
    return out.index_add_(0, seg, src)

def _pad(x, pw):
    flat = tuple((v for pair in reversed(pw) for v in pair))
    return torch.nn.functional.pad(x, flat)
kernel_name = 'standalone__molecular_angular_painn__graph'

def setup_inputs():

    _w = lambda a: (lambda t: t.to(torch.bfloat16) if t.is_floating_point() else t)(torch.as_tensor(a))
    N, deg, D = (12500, 32, 128)
    n_rbf = max(4, 4)
    E = N * deg
    cutoff = 5.0
    freqs = (torch.arange(1, n_rbf + 1) * torch.pi / cutoff).to(float)
    return {'sv': _w((lambda *s: torch.randn(*s, dtype=torch.bfloat16) * 0.4)(N, 4, D) * 0.3), 'pos': _w((lambda *s: torch.randn(*s, dtype=torch.bfloat16) * 3.2)(N, 3) * 1.2), 'src': _w((lambda lo, hi, *s: torch.randint(lo, hi, s))(0, N, E).to(torch.int64)), 'dst': _w((lambda lo, hi, *s: torch.randint(lo, hi, s))(0, N, E).to(torch.int64)), 'freqs': _w(freqs), 'w_phi1': _w((lambda *s: torch.randn(*s, dtype=torch.bfloat16) * 3.2)(D, D) / D ** 0.5), 'w_phi2': _w((lambda *s: torch.randn(*s, dtype=torch.bfloat16) * 3.2)(D, 3 * D) / D ** 0.5), 'w_rbf': _w((lambda *s: torch.randn(*s, dtype=torch.bfloat16) * 3.2)(n_rbf, 3 * D) / n_rbf ** 0.5)}

def reference(sv, pos, src, dst, freqs, w_phi1, w_phi2, w_rbf):
    N, _, D = sv.shape
    E = src.shape[0]
    PI, cutoff = (3.141592653589793, 5.0)
    s, v = (sv[:, 0, :].clone(), sv[:, 1:, :].clone())
    r_vec = pos[src] - pos[dst]
    d = torch.sqrt((r_vec * r_vec).sum(-1) + 1e-08)
    r_hat = r_vec / d[:, None]
    rbf = torch.sin(d[:, None] * freqs[None, :]) / d[:, None]
    fcut = 0.5 * (torch.cos(PI * d / cutoff) + 1.0)
    fcut = torch.where(d < cutoff, fcut, 0.0 * d)
    Wf = rbf @ w_rbf * fcut[:, None]
    phi = (_silu(s @ w_phi1) @ w_phi2)[src]
    m = phi * Wf
    m_s, m_vv, m_vr = (m[:, :D].clone(), m[:, D:2 * D].clone(), m[:, 2 * D:].clone())
    ds = _segment_sum(m_s, dst, N)
    dv_e = m_vv[:, None, :] * v[src] + m_vr[:, None, :] * r_hat[:, :, None]
    dv = _segment_sum(dv_e.reshape(E, 3 * D), dst, N).reshape(N, 3, D)
    return sv + torch.concatenate([ds[:, None, :], dv], axis=1)
```

```asm
; @launch kernel=k1_kernel grid=(250,1,1) block=(512,1,1) lds=160256
; @launch kernel=k2_kernel grid=(250,1,1) block=(512,1,1) lds=163136
.amdgcn_target "amdgcn-amd-amdhsa--gfx950"
.text
.globl k1_kernel
.p2align 8
.type k1_kernel,@function
k1_kernel:
  s_getpc_b64 s[48:49]
CPF0:
  v_lshlrev_b32 v118, 7, v0
  s_add_u32 s48, s48, k1_kernel-CPF0
  s_addc_u32 s49, s49, (k1_kernel-CPF0)>>31>>1
  v_min_u32 v118, K2_CODE_END-k1_kernel-4, v118
  global_load_dword v119, v118, s[48:49]
  s_cmp_ge_u32 s2, 250
  s_cbranch_scc1 K1_END
  s_load_dwordx4 s[4:7], s[0:1], 0
  s_load_dwordx4 s[8:11], s[0:1], 16
  s_load_dwordx4 s[12:15], s[0:1], 40
  s_load_dwordx2 s[16:17], s[0:1], 56
  s_load_dwordx2 s[18:19], s[0:1], 80
  v_lshrrev_b32 v2, 6, v0
  v_and_b32 v1, 63, v0
  v_readfirstlane_b32 s36, v2
  v_mov_b32 v4, 0
  v_mov_b32 v5, 0
  v_lshlrev_b32 v3, 2, v0
  v_add_u32 v6, 75776, v3
  ds_write_b32 v6, v4
  v_mov_b32 v7, 92160
  ds_write_b64 v7, v[4:5]
  s_mul_i32 s37, s2, 6400
  s_add_u32 s38, s37, 4096
  v_lshlrev_b32 v9, 4, v1
  s_and_b32 s39, s36, 3
  s_lshr_b32 s33, s36, 2
  s_mul_i32 s32, s2, 50
  v_lshrrev_b32 v10, 4, v1
  v_and_b32 v11, 15, v1
  v_lshrrev_b32 v12, 2, v11
  v_xor_b32 v12, v12, v10
  v_lshlrev_b32 v12, 2, v12
  v_and_b32 v13, 3, v11
  v_add_u32 v12, v12, v13
  v_lshlrev_b32 v12, 4, v12
  v_lshl_add_u32 v12, v10, 8, v12
  v_and_b32 v13, 1, v10
  v_xor_b32 v13, v13, v11
  v_lshlrev_b32 v13, 4, v13
  v_lshlrev_b32 v14, 3, v10
  s_waitcnt lgkmcnt(0)
  s_mov_b32 s20, s8
  s_mov_b32 s21, s9
  s_mov_b32 s22, 1600000
  s_mov_b32 s23, 0x20000
  s_mov_b32 s24, s10
  s_mov_b32 s25, s11
  s_mov_b32 s26, 1600000
  s_mov_b32 s27, 0x20000
  buffer_load_dword v20, v3, s[20:23], s37 offen offset:0
  buffer_load_dword v24, v3, s[24:27], s37 offen offset:0
  buffer_load_dword v21, v3, s[20:23], s37 offen offset:2048
  buffer_load_dword v25, v3, s[24:27], s37 offen offset:2048
  buffer_load_dword v22, v3, s[20:23], s38 offen offset:0
  buffer_load_dword v26, v3, s[24:27], s38 offen offset:0
  buffer_load_dword v23, v3, s[20:23], s38 offen offset:2048
  buffer_load_dword v27, v3, s[24:27], s38 offen offset:2048
  s_mov_b32 s40, s4
  s_mov_b32 s41, s5
  s_mov_b32 s42, 12800000
  s_mov_b32 s43, 0x20000
  s_mov_b32 s28, s6
  s_mov_b32 s29, s7
  s_mov_b32 s30, 75000
  s_mov_b32 s31, 0x20000
  s_mov_b32 s44, s12
  s_mov_b32 s45, s13
  s_mov_b32 s46, 32768
  s_mov_b32 s47, 0x20000
  s_mov_b32 s52, s18
  s_mov_b32 s53, s19
  s_mov_b32 s54, 7553024
  s_mov_b32 s55, 0x20000
  s_lshl_b32 s48, s36, 1
  s_add_u32 s48, s48, 0
  s_lshr_b32 s49, s48, 3
  s_and_b32 s48, s48, 7
  s_lshl_b32 s50, s49, 5
  s_add_u32 s50, s50, s48
  v_add_u32 v15, s50, v14
  v_cmp_gt_u32 vcc, 50, v15
  v_add_u32 v16, s32, v15
  v_lshl_add_u32 v16, v16, 10, v13
  v_mov_b32 v17, 0x7f000000
  v_cndmask_b32 v16, v17, v16, vcc
  s_mul_i32 s51, s49, 8448
  s_mul_i32 s50, s48, 1056
  s_add_u32 s51, s51, s50
  s_add_u32 m0, s51, 125952
  s_nop 0
  buffer_load_dwordx4 v16, s[40:43], 0 offen  lds
  s_lshl_b32 s48, s36, 1
  s_add_u32 s48, s48, 1
  s_lshr_b32 s49, s48, 3
  s_and_b32 s48, s48, 7
  s_lshl_b32 s50, s49, 5
  s_add_u32 s50, s50, s48
  v_add_u32 v15, s50, v14
  v_cmp_gt_u32 vcc, 50, v15
  v_add_u32 v16, s32, v15
  v_lshl_add_u32 v16, v16, 10, v13
  v_mov_b32 v17, 0x7f000000
  v_cndmask_b32 v16, v17, v16, vcc
  s_mul_i32 s51, s49, 8448
  s_mul_i32 s50, s48, 1056
  s_add_u32 s51, s51, s50
  s_add_u32 m0, s51, 125952
  s_nop 0
  buffer_load_dwordx4 v16, s[40:43], 0 offen  lds
  s_lshl_b32 s48, s36, 12
  s_add_u32 m0, s48, 93184
  s_nop 0
  buffer_load_dwordx4 v12, s[44:47], s48 offen offset:0 lds
  buffer_load_dwordx4 v12, s[44:47], s48 offen offset:1024 lds
  buffer_load_dwordx4 v12, s[44:47], s48 offen offset:2048 lds
  buffer_load_dwordx4 v12, s[44:47], s48 offen offset:3072 lds
  s_mul_i32 s48, s36, 10240
  s_add_u32 s49, s48, 0
  s_mov_b32 m0, s49
  s_nop 0
  buffer_load_dwordx4 v9, s[28:31], s49 offen offset:0 lds
  buffer_load_dwordx4 v9, s[28:31], s49 offen offset:1024 lds
  buffer_load_dwordx4 v9, s[28:31], s49 offen offset:2048 lds
  buffer_load_dwordx4 v9, s[28:31], s49 offen offset:3072 lds
  s_add_u32 s49, s48, 4096
  s_mov_b32 m0, s49
  s_nop 0
  s_cmp_eq_u32 s36, 7
  s_cbranch_scc1 K1_POSDONE
  buffer_load_dwordx4 v9, s[28:31], s49 offen offset:0 lds
  buffer_load_dwordx4 v9, s[28:31], s49 offen offset:1024 lds
  buffer_load_dwordx4 v9, s[28:31], s49 offen offset:2048 lds
  buffer_load_dwordx4 v9, s[28:31], s49 offen offset:3072 lds
  s_add_u32 s49, s48, 8192
  s_mov_b32 m0, s49
  s_nop 0
  buffer_load_dwordx4 v9, s[28:31], s49 offen offset:0 lds
  buffer_load_dwordx4 v9, s[28:31], s49 offen offset:1024 lds
K1_POSDONE:
  s_cmp_lg_u32 s36, 7
  s_cbranch_scc1 K1_NOREL1
  s_cmp_lt_u32 s2, 108
  s_cbranch_scc1 K1_REL1
K1_NOREL1:
  s_mov_b32 s56, 0x41c9999a
  s_movk_i32 s57, 5243
  s_mov_b32 s58, 0xffff0000
  v_mov_b32 v8, 1
  s_waitcnt vmcnt(10)
  v_mul_u32_u24 v28, 6, v20
  v_and_b32 v36, 2, v28
  v_and_b32 v28, -4, v28
  v_lshlrev_b32 v36, 3, v36
  v_mul_u32_u24 v29, 6, v24
  v_and_b32 v37, 2, v29
  v_and_b32 v29, -4, v29
  v_lshlrev_b32 v37, 3, v37
  v_mul_u32_u24 v44, s57, v24
  v_lshrrev_b32 v44, 17, v44
  v_mul_u32_u24 v2, 25, v44
  v_sub_u32 v2, v24, v2
  v_lshl_or_b32 v48, v2, 14, v20
  v_mul_u32_u24 v52, 24, v44
  v_add_u32 v52, 77824, v52
  v_lshlrev_b32 v44, 2, v44
  v_add_u32 v44, 75776, v44
  v_mul_u32_u24 v30, 6, v21
  v_and_b32 v38, 2, v30
  v_and_b32 v30, -4, v30
  v_lshlrev_b32 v38, 3, v38
  v_mul_u32_u24 v31, 6, v25
  v_and_b32 v39, 2, v31
  v_and_b32 v31, -4, v31
  v_lshlrev_b32 v39, 3, v39
  v_mul_u32_u24 v45, s57, v25
  v_lshrrev_b32 v45, 17, v45
  v_mul_u32_u24 v2, 25, v45
  v_sub_u32 v2, v25, v2
  v_lshl_or_b32 v49, v2, 14, v21
  v_mul_u32_u24 v53, 24, v45
  v_add_u32 v53, 77824, v53
  v_lshlrev_b32 v45, 2, v45
  v_add_u32 v45, 75776, v45
  v_mul_u32_u24 v32, 6, v22
  v_and_b32 v40, 2, v32
  v_and_b32 v32, -4, v32
  v_lshlrev_b32 v40, 3, v40
  v_mul_u32_u24 v33, 6, v26
  v_and_b32 v41, 2, v33
  v_and_b32 v33, -4, v33
  v_lshlrev_b32 v41, 3, v41
  v_mul_u32_u24 v46, s57, v26
  v_lshrrev_b32 v46, 17, v46
  v_mul_u32_u24 v2, 25, v46
  v_sub_u32 v2, v26, v2
  v_lshl_or_b32 v50, v2, 14, v22
  v_mul_u32_u24 v54, 24, v46
  v_add_u32 v54, 77824, v54
  v_lshlrev_b32 v46, 2, v46
  v_add_u32 v46, 75776, v46
  v_mul_u32_u24 v34, 6, v23
  v_and_b32 v42, 2, v34
  v_and_b32 v34, -4, v34
  v_lshlrev_b32 v42, 3, v42
  v_mul_u32_u24 v35, 6, v27
  v_and_b32 v43, 2, v35
  v_and_b32 v35, -4, v35
  v_lshlrev_b32 v43, 3, v43
  v_mul_u32_u24 v47, s57, v27
  v_lshrrev_b32 v47, 17, v47
  v_mul_u32_u24 v2, 25, v47
  v_sub_u32 v2, v27, v2
  v_lshl_or_b32 v51, v2, 14, v23
  v_mul_u32_u24 v55, 24, v47
  v_add_u32 v55, 77824, v55
  v_lshlrev_b32 v47, 2, v47
  v_add_u32 v47, 75776, v47
  v_cmp_gt_u32 s[60:61], 64, v0
  v_lshrrev_b32 v15, 5, v1
  v_bfe_u32 v16, v1, 2, 2
  v_lshl_add_u32 v17, v15, 3, v16
  v_lshlrev_b32 v60, 8, v17
  v_xor_b32 v16, s39, v16
  v_lshl_add_u32 v60, v16, 6, v60
  v_bfe_u32 v16, v1, 4, 1
  v_lshl_add_u32 v60, v16, 5, v60
  v_and_b32 v16, 3, v1
  v_lshl_add_u32 v60, v16, 3, v60
  v_add_u32 v60, 93184, v60
  v_and_b32 v16, 7, v1
  v_mul_u32_u24 v61, 1056, v16
  v_bfe_u32 v16, v1, 3, 2
  v_lshl_add_u32 v61, v16, 8, v61
  v_and_b32 v16, 1, v16
  v_xor_b32 v16, v16, v15
  v_lshl_add_u32 v61, v16, 4, v61
  s_mul_i32 s48, s33, 8448
  s_add_u32 s48, s48, 125952
  v_add_u32 v61, s48, v61
  v_and_b32 v16, 31, v1
  s_lshl_b32 s48, s33, 5
  v_add_u32 v16, s48, v16
  v_mul_u32_u24 v62, 272, v16
  v_lshl_add_u32 v62, v15, 5, v62
  s_lshl_b32 s48, s39, 6
  s_add_u32 s48, s48, 142848
  v_add_u32 v62, s48, v62
  s_waitcnt vmcnt(0)
  s_barrier
  s_cmp_ge_u32 s36, 4
  s_cbranch_scc1 K1_NOVPF
  s_mul_i32 s48, s2, 51200
  s_lshl_b32 s49, s36, 13
  s_add_u32 s48, s48, s49
  v_lshlrev_b32 v170, 7, v1
  buffer_load_dword v171, v170, s[40:43], s48 offen
K1_NOVPF:
  ds_read2_b32 v[144:145], v28 offset0:0 offset1:1
  ds_read2_b32 v[146:147], v29 offset0:0 offset1:1
  ds_read2_b32 v[148:149], v30 offset0:0 offset1:1
  ds_read2_b32 v[150:151], v31 offset0:0 offset1:1
  ds_read2_b32 v[152:153], v32 offset0:0 offset1:1
  ds_read2_b32 v[154:155], v33 offset0:0 offset1:1
  ds_read2_b32 v[156:157], v34 offset0:0 offset1:1
  ds_read2_b32 v[158:159], v35 offset0:0 offset1:1
  ds_read_b64_tr_b16 v[64:65], v60 offset:0
  ds_read_b64_tr_b16 v[66:67], v60 offset:1024
  ds_read_b128 v[96:99], v61 offset:0
  ds_read_b64_tr_b16 v[68:69], v60 offset:4096
  ds_read_b64_tr_b16 v[70:71], v60 offset:5120
  ds_read_b128 v[100:103], v61 offset:32
  s_waitcnt lgkmcnt(12)
  v_alignbit_b32 v166, v145, v144, v36
  v_lshrrev_b32 v162, v36, v145
  v_lshlrev_b32 v160, 16, v166
  v_and_b32 v161, s58, v166
  v_lshlrev_b32 v162, 16, v162
  v_alignbit_b32 v169, v147, v146, v37
  v_lshrrev_b32 v165, v37, v147
  v_lshlrev_b32 v163, 16, v169
  v_and_b32 v164, s58, v169
  v_lshlrev_b32 v165, 16, v165
  v_sub_f32 v160, v160, v163
  v_sub_f32 v161, v161, v164
  v_sub_f32 v162, v162, v165
  v_mul_f32 v160, v160, v160
  v_fmac_f32 v160, v161, v161
  v_fmac_f32 v160, v162, v162
  v_cmp_gt_f32 s[62:63], s56, v160
  s_waitcnt lgkmcnt(10)
  v_alignbit_b32 v166, v149, v148, v38
  v_lshrrev_b32 v162, v38, v149
  v_lshlrev_b32 v160, 16, v166
  v_and_b32 v161, s58, v166
  v_lshlrev_b32 v162, 16, v162
  v_alignbit_b32 v169, v151, v150, v39
  v_lshrrev_b32 v165, v39, v151
  v_lshlrev_b32 v163, 16, v169
  v_and_b32 v164, s58, v169
  v_lshlrev_b32 v165, 16, v165
  v_sub_f32 v160, v160, v163
  v_sub_f32 v161, v161, v164
  v_sub_f32 v162, v162, v165
  v_mul_f32 v160, v160, v160
  v_fmac_f32 v160, v161, v161
  v_fmac_f32 v160, v162, v162
  v_cmp_gt_f32 s[64:65], s56, v160
  s_waitcnt lgkmcnt(8)
  v_alignbit_b32 v166, v153, v152, v40
  v_lshrrev_b32 v162, v40, v153
  v_lshlrev_b32 v160, 16, v166
  v_and_b32 v161, s58, v166
  v_lshlrev_b32 v162, 16, v162
  v_alignbit_b32 v169, v155, v154, v41
  v_lshrrev_b32 v165, v41, v155
  v_lshlrev_b32 v163, 16, v169
  v_and_b32 v164, s58, v169
  v_lshlrev_b32 v165, 16, v165
  v_sub_f32 v160, v160, v163
  v_sub_f32 v161, v161, v164
  v_sub_f32 v162, v162, v165
  v_mul_f32 v160, v160, v160
  v_fmac_f32 v160, v161, v161
  v_fmac_f32 v160, v162, v162
  v_cmp_gt_f32 s[66:67], s56, v160
  s_waitcnt lgkmcnt(6)
  v_alignbit_b32 v166, v157, v156, v42
  v_lshrrev_b32 v162, v42, v157
  v_lshlrev_b32 v160, 16, v166
  v_and_b32 v161, s58, v166
  v_lshlrev_b32 v162, 16, v162
  v_alignbit_b32 v169, v159, v158, v43
  v_lshrrev_b32 v165, v43, v159
  v_lshlrev_b32 v163, 16, v169
  v_and_b32 v164, s58, v169
  v_lshlrev_b32 v165, 16, v165
  v_sub_f32 v160, v160, v163
  v_sub_f32 v161, v161, v164
  v_sub_f32 v162, v162, v165
  v_mul_f32 v160, v160, v160
  v_fmac_f32 v160, v161, v161
  v_fmac_f32 v160, v162, v162
  v_cmp_gt_f32 s[68:69], s56, v160
  s_nop 0
  s_and_b64 s[68:69], s[68:69], s[60:61]
  s_mov_b64 exec, s[62:63]
  ds_add_rtn_u32 v56, v44, v8
  s_mov_b64 exec, s[64:65]
  ds_add_rtn_u32 v57, v45, v8
  s_mov_b64 exec, s[66:67]
  ds_add_rtn_u32 v58, v46, v8
  s_mov_b64 exec, s[68:69]
  ds_add_rtn_u32 v59, v47, v8
  s_mov_b64 exec, -1
  ds_read_b64_tr_b16 v[72:73], v60 offset:8192
  ds_read_b64_tr_b16 v[74:75], v60 offset:9216
  ds_read_b128 v[104:107], v61 offset:64
  s_waitcnt lgkmcnt(10)
  v_mfma_f32_32x32x16_bf16 v[128:143], v[64:67], v[96:99], 0
  ds_read_b64_tr_b16 v[76:77], v60 offset:12288
  ds_read_b64_tr_b16 v[78:79], v60 offset:13312
  ds_read_b128 v[108:111], v61 offset:96
  s_waitcnt lgkmcnt(10)
  v_mfma_f32_32x32x16_bf16 v[128:143], v[68:71], v[100:103], v[128:143]
  ds_read_b64_tr_b16 v[80:81], v60 offset:16384
  ds_read_b64_tr_b16 v[82:83], v60 offset:17408
  ds_read_b128 v[112:115], v61 offset:128
  s_waitcnt lgkmcnt(9)
  v_lshl_add_u32 v52, v56, 2, v52
  v_cmp_gt_u32 vcc, 6, v56
  s_and_b64 exec, vcc, s[62:63]
  ds_write_b32 v52, v48
  s_mov_b64 exec, -1
  v_lshl_add_u32 v53, v57, 2, v53
  v_cmp_gt_u32 vcc, 6, v57
  s_and_b64 exec, vcc, s[64:65]
  ds_write_b32 v53, v49
  s_mov_b64 exec, -1
  v_lshl_add_u32 v54, v58, 2, v54
  v_cmp_gt_u32 vcc, 6, v58
  s_and_b64 exec, vcc, s[66:67]
  ds_write_b32 v54, v50
  s_mov_b64 exec, -1
  v_lshl_add_u32 v55, v59, 2, v55
  v_cmp_gt_u32 vcc, 6, v59
  s_and_b64 exec, vcc, s[68:69]
  ds_write_b32 v55, v51
  s_mov_b64 exec, -1
  s_waitcnt lgkmcnt(10)
  v_mfma_f32_32x32x16_bf16 v[128:143], v[72:75], v[104:107], v[128:143]
  ds_read_b64_tr_b16 v[84:85], v60 offset:20480
  ds_read_b64_tr_b16 v[86:87], v60 offset:21504
  ds_read_b128 v[116:119], v61 offset:160
  s_waitcnt lgkmcnt(10)
  v_mfma_f32_32x32x16_bf16 v[128:143], v[76:79], v[108:111], v[128:143]
  ds_read_b64_tr_b16 v[88:89], v60 offset:24576
  ds_read_b64_tr_b16 v[90:91], v60 offset:25600
  ds_read_b128 v[120:123], v61 offset:192
  s_waitcnt lgkmcnt(10)
  v_mfma_f32_32x32x16_bf16 v[128:143], v[80:83], v[112:115], v[128:143]
  ds_read_b64_tr_b16 v[92:93], v60 offset:28672
  ds_read_b64_tr_b16 v[94:95], v60 offset:29696
  ds_read_b128 v[124:127], v61 offset:224
  s_waitcnt lgkmcnt(6)
  v_mfma_f32_32x32x16_bf16 v[128:143], v[84:87], v[116:119], v[128:143]
  s_waitcnt lgkmcnt(3)
  v_mfma_f32_32x32x16_bf16 v[128:143], v[88:91], v[120:123], v[128:143]
  s_waitcnt lgkmcnt(0)
  v_mfma_f32_32x32x16_bf16 v[128:143], v[92:95], v[124:127], v[128:143]
  s_cmp_lg_u32 s36, 7
  s_cbranch_scc1 K1_NOREL2
  s_cmp_lt_u32 s2, 108
  s_cbranch_scc1 K1_REL2
K1_NOREL2:
  s_mov_b32 s51, 0xbfb8aa3b
  v_mov_b32 v66, s51
  v_mov_b32 v67, s51
  v_mov_b32 v64, 1.0
  v_mov_b32 v65, 1.0
  s_nop 7
  v_pk_mul_f32 v[96:97], v[128:129], v[66:67]
  v_pk_mul_f32 v[98:99], v[130:131], v[66:67]
  v_pk_mul_f32 v[100:101], v[132:133], v[66:67]
  v_pk_mul_f32 v[102:103], v[134:135], v[66:67]
  v_pk_mul_f32 v[104:105], v[136:137], v[66:67]
  v_pk_mul_f32 v[106:107], v[138:139], v[66:67]
  v_pk_mul_f32 v[108:109], v[140:141], v[66:67]
  v_pk_mul_f32 v[110:111], v[142:143], v[66:67]
  v_exp_f32 v96, v96
  v_exp_f32 v97, v97
  v_exp_f32 v98, v98
  v_exp_f32 v99, v99
  v_exp_f32 v100, v100
  v_exp_f32 v101, v101
  v_exp_f32 v102, v102
  v_exp_f32 v103, v103
  v_exp_f32 v104, v104
  v_exp_f32 v105, v105
  v_exp_f32 v106, v106
  v_exp_f32 v107, v107
  v_exp_f32 v108, v108
  v_exp_f32 v109, v109
  v_exp_f32 v110, v110
  v_exp_f32 v111, v111
  v_pk_add_f32 v[96:97], v[96:97], v[64:65]
  v_pk_add_f32 v[98:99], v[98:99], v[64:65]
  v_pk_add_f32 v[100:101], v[100:101], v[64:65]
  v_pk_add_f32 v[102:103], v[102:103], v[64:65]
  v_pk_add_f32 v[104:105], v[104:105], v[64:65]
  v_pk_add_f32 v[106:107], v[106:107], v[64:65]
  v_pk_add_f32 v[108:109], v[108:109], v[64:65]
  v_pk_add_f32 v[110:111], v[110:111], v[64:65]
  v_rcp_f32 v96, v96
  v_rcp_f32 v97, v97
  v_rcp_f32 v98, v98
  v_rcp_f32 v99, v99
  v_rcp_f32 v100, v100
  v_rcp_f32 v101, v101
  v_rcp_f32 v102, v102
  v_rcp_f32 v103, v103
  v_rcp_f32 v104, v104
  v_rcp_f32 v105, v105
  v_rcp_f32 v106, v106
  v_rcp_f32 v107, v107
  v_rcp_f32 v108, v108
  v_rcp_f32 v109, v109
  v_rcp_f32 v110, v110
  v_rcp_f32 v111, v111
  s_nop 0
  v_pk_mul_f32 v[96:97], v[96:97], v[128:129]
  v_pk_mul_f32 v[98:99], v[98:99], v[130:131]
  v_pk_mul_f32 v[100:101], v[100:101], v[132:133]
  v_pk_mul_f32 v[102:103], v[102:103], v[134:135]
  v_pk_mul_f32 v[104:105], v[104:105], v[136:137]
  v_pk_mul_f32 v[106:107], v[106:107], v[138:139]
  v_pk_mul_f32 v[108:109], v[108:109], v[140:141]
  v_pk_mul_f32 v[110:111], v[110:111], v[142:143]
  v_cvt_pk_bf16_f32 v112, v96, v97
  v_cvt_pk_bf16_f32 v113, v98, v99
  v_cvt_pk_bf16_f32 v114, v100, v101
  v_cvt_pk_bf16_f32 v115, v102, v103
  v_cvt_pk_bf16_f32 v116, v104, v105
  v_cvt_pk_bf16_f32 v117, v106, v107
  v_cvt_pk_bf16_f32 v118, v108, v109
  v_cvt_pk_bf16_f32 v119, v110, v111
  ds_write_b128 v62, v[112:115]
  ds_write_b128 v62, v[116:119] offset:16
  v_bfe_u32 v20, v0, 1, 5
  v_lshrrev_b32 v21, 6, v0
  v_lshl_add_u32 v20, v20, 3, v21
  v_and_b32 v21, 1, v0
  v_lshl_add_u32 v20, v20, 1, v21
  v_lshlrev_b32 v21, 2, v20
  v_mul_u32_u24 v22, 24, v20
  v_add_u32 v21, 75776, v21
  v_add_u32 v22, 77824, v22
  v_lshlrev_b32 v23, 4, v0
  s_mov_b32 s48, 0x7ffff
  s_mul_i32 s49, s2, 8192
  s_add_u32 s49, s49, 3407872
  s_mul_i32 s50, s2, 8192
  s_add_u32 s50, s50, 5505024
  s_lshl_b32 s51, s36, 2
  v_add_u32 v24, s51, v10
  v_mul_u32_u24 v25, 272, v24
  v_lshl_add_u32 v25, v11, 4, v25
  v_add_u32 v25, 142848, v25
  v_add_u32 v26, s32, v24
  v_lshlrev_b32 v26, 8, v26
  v_lshl_add_u32 v26, v11, 4, v26
  s_mov_b32 s44, s18
  s_mov_b32 s45, s19
  s_mov_b32 s46, 3200000
  s_mov_b32 s47, 0x20000
  s_waitcnt lgkmcnt(0)
  s_barrier
  ds_read_b32 v28, v21
  ds_read_b64 v[30:31], v22
  ds_read_b64 v[32:33], v22 offset:8
  ds_read_b64 v[34:35], v22 offset:16
  ds_read_b128 v[64:67], v25
  ds_read_b128 v[68:71], v25 offset:8704
  s_waitcnt lgkmcnt(1)
  buffer_store_dwordx4 v[64:67], v26, s[44:47], 0 offen sc1
  v_and_b32 v30, s48, v30
  v_and_b32 v31, s48, v31
  v_and_b32 v32, s48, v32
  v_and_b32 v33, s48, v33
  v_and_b32 v34, s48, v34
  v_and_b32 v35, s48, v35
  v_lshl_or_b32 v36, v31, 19, v30
  v_lshrrev_b32 v37, 13, v31
  v_lshl_or_b32 v37, v32, 6, v37
  v_lshl_or_b32 v37, v33, 25, v37
  v_lshrrev_b32 v38, 7, v33
  v_lshl_or_b32 v38, v34, 12, v38
  v_lshl_or_b32 v38, v35, 31, v38
  v_lshrrev_b32 v39, 1, v35
  v_cmp_lt_u32 vcc, 6, v28
  s_cmp_lg_u64 vcc, 0
  s_cbranch_scc1 K1_OVF
K1_OVF_RET:
  v_lshl_or_b32 v39, v28, 18, v39
  buffer_store_dwordx4 v[36:39], v23, s[52:55], s49 offen sc1
  v_cmp_gt_u32 vcc, 18, v24
  s_waitcnt lgkmcnt(0)
  s_and_saveexec_b64 s[70:71], vcc
  s_cbranch_execz K1_NOH2
  v_add_u32 v26, 8192, v26
  buffer_store_dwordx4 v[68:71], v26, s[44:47], 0 offen sc1
K1_NOH2:
  s_mov_b64 exec, -1
  s_barrier
  ds_read_b32 v9, v7 offset:4
  s_waitcnt lgkmcnt(0)
  v_readfirstlane_b32 s51, v9
  s_nop 3
  s_cmp_lg_u32 s51, 0
  s_cbranch_scc1 K1_OVF2
K1_END:
  s_endpgm
K1_OVF:
  s_and_saveexec_b64 s[70:71], vcc
  v_add_u32 v29, 1, v28
  ds_add_rtn_u32 v29, v7, v29
  ds_write_b32 v7, v8 offset:4
  s_waitcnt lgkmcnt(0)
  ds_write_b32 v21, v29 offset:14336
  v_lshlrev_b32 v27, 2, v29
  buffer_store_dword v28, v27, s[52:55], s50 offen
  v_lshl_or_b32 v28, v29, 3, 7
  s_mov_b64 exec, s[70:71]
  s_branch K1_OVF_RET
K1_OVF2:
  s_mov_b64 exec, s[62:63]
  ds_read_b32 v12, v44
  ds_read_b32 v13, v44 offset:14336
  s_waitcnt lgkmcnt(0)
  v_cmp_lt_u32 vcc, 6, v12
  s_and_b64 exec, exec, vcc
  s_cbranch_execz K1_OV0
  v_add3_u32 v13, v13, v56, 1
  v_lshlrev_b32 v13, 2, v13
  buffer_store_dword v48, v13, s[52:55], s50 offen
K1_OV0:
  s_mov_b64 exec, s[64:65]
  ds_read_b32 v12, v45
  ds_read_b32 v13, v45 offset:14336
  s_waitcnt lgkmcnt(0)
  v_cmp_lt_u32 vcc, 6, v12
  s_and_b64 exec, exec, vcc
  s_cbranch_execz K1_OV1
  v_add3_u32 v13, v13, v57, 1
  v_lshlrev_b32 v13, 2, v13
  buffer_store_dword v49, v13, s[52:55], s50 offen
K1_OV1:
  s_mov_b64 exec, s[66:67]
  ds_read_b32 v12, v46
  ds_read_b32 v13, v46 offset:14336
  s_waitcnt lgkmcnt(0)
  v_cmp_lt_u32 vcc, 6, v12
  s_and_b64 exec, exec, vcc
  s_cbranch_execz K1_OV2
  v_add3_u32 v13, v13, v58, 1
  v_lshlrev_b32 v13, 2, v13
  buffer_store_dword v50, v13, s[52:55], s50 offen
K1_OV2:
  s_mov_b64 exec, s[68:69]
  ds_read_b32 v12, v47
  ds_read_b32 v13, v47 offset:14336
  s_waitcnt lgkmcnt(0)
  v_cmp_lt_u32 vcc, 6, v12
  s_and_b64 exec, exec, vcc
  s_cbranch_execz K1_OV3
  v_add3_u32 v13, v13, v59, 1
  v_lshlrev_b32 v13, 2, v13
  buffer_store_dword v51, v13, s[52:55], s50 offen
K1_OV3:
  s_mov_b64 exec, -1
  s_endpgm
K1_REL1:
  s_mov_b32 s72, s14
  s_mov_b32 s73, s15
  s_mov_b32 s74, 98304
  s_mov_b32 s75, 0x20000
  s_mov_b32 s76, s16
  s_mov_b32 s77, s17
  s_mov_b32 s78, 3072
  s_mov_b32 s79, 0x20000
  v_and_b32 v100, 31, v1
  v_lshrrev_b32 v101, 5, v1
  v_bfe_u32 v102, v100, 2, 1
  v_lshlrev_b32 v102, 4, v102
  v_lshrrev_b32 v103, 3, v100
  v_lshl_add_u32 v102, v103, 2, v102
  v_and_b32 v103, 3, v100
  v_add_u32 v102, v102, v103
  s_cmp_ge_u32 s2, 96
  s_cbranch_scc1 K1_REL_WR
  s_mul_i32 s48, s2, 2731
  s_lshr_b32 s48, s48, 16
  s_mul_i32 s49, s48, 24
  s_sub_u32 s49, s2, s49
  s_lshr_b32 s50, s49, 3
  s_and_b32 s51, s49, 7
  s_lshl_b32 s80, s50, 7
  s_lshl_b32 s81, s48, 5
  s_add_u32 s80, s80, s81
  v_add_u32 v102, s80, v102
  v_lshlrev_b32 v102, 1, v102
  s_lshr_b32 s81, s51, 1
  s_lshl_b32 s81, s81, 5
  s_and_b32 s80, s51, 1
  s_lshl_b32 s80, s80, 2
  s_add_u32 s81, s81, s80
  v_lshlrev_b32 v103, 4, v101
  v_add_u32 v103, s81, v103
  v_mul_u32_u24 v103, 768, v103
  v_add_u32 v103, v103, v102
  v_add_u32 v104, 6144, v103
  buffer_load_ushort v172, v103, s[72:75], 0 offen offset:0
  buffer_load_ushort v173, v103, s[72:75], 0 offen offset:768
  buffer_load_ushort v174, v103, s[72:75], 0 offen offset:1536
  buffer_load_ushort v175, v103, s[72:75], 0 offen offset:2304
  buffer_load_ushort v176, v104, s[72:75], 0 offen offset:0
  buffer_load_ushort v177, v104, s[72:75], 0 offen offset:768
  buffer_load_ushort v178, v104, s[72:75], 0 offen offset:1536
  buffer_load_ushort v179, v104, s[72:75], 0 offen offset:2304
  s_branch K1_NOREL1
K1_REL_WR:
  s_sub_u32 s48, s2, 96
  s_mul_i32 s49, s48, 86
  s_lshr_b32 s49, s49, 8
  s_mul_i32 s50, s49, 3
  s_sub_u32 s50, s48, s50
  s_lshl_b32 s80, s50, 7
  s_lshl_b32 s81, s49, 5
  s_add_u32 s80, s80, s81
  v_add_u32 v102, s80, v102
  v_lshlrev_b32 v102, 1, v102
  buffer_load_ushort v172, v102, s[76:79], 0 offen offset:0
  buffer_load_ushort v173, v102, s[76:79], 0 offen offset:768
  buffer_load_ushort v174, v102, s[76:79], 0 offen offset:1536
  buffer_load_ushort v175, v102, s[76:79], 0 offen offset:2304
  s_branch K1_NOREL1
K1_REL2:
  v_lshl_or_b32 v180, v173, 16, v172
  v_lshl_or_b32 v181, v175, 16, v174
  v_lshl_or_b32 v182, v177, 16, v176
  v_lshl_or_b32 v183, v179, 16, v178
  s_cmp_ge_u32 s2, 96
  s_cbranch_scc1 K1_REL_WR2
  s_lshl_b32 s48, s2, 10
  s_add_u32 s48, s48, 3211264
  buffer_store_dwordx4 v[180:183], v9, s[52:55], s48 offen sc1
  s_branch K1_NOREL2
K1_REL_WR2:
  v_cmp_gt_u32 vcc, 32, v1
  s_nop 1
  v_cndmask_b32 v180, 0, v180, vcc
  v_cndmask_b32 v181, 0, v181, vcc
  s_sub_u32 s48, s2, 96
  s_lshl_b32 s48, s48, 9
  s_add_u32 s48, s48, 3309568
  v_lshlrev_b32 v170, 3, v1
  buffer_store_dwordx2 v[180:181], v170, s[52:55], s48 offen
  s_branch K1_NOREL2
.globl k2_kernel
.p2align 8
.type k2_kernel,@function
k2_kernel:
  s_getpc_b64 s[56:57]
CPF1:
  v_lshlrev_b32 v13, 7, v0
  s_add_u32 s56, s56, k2_kernel-CPF1
  s_addc_u32 s57, s57, (k2_kernel-CPF1)>>31>>1
  v_min_u32 v13, K2_CODE_END-k2_kernel-4, v13
  global_load_dword v94, v13, s[56:57]
  s_cmp_ge_u32 s2, 250
  s_cbranch_scc1 K2_END
  s_load_dwordx4 s[4:7], s[0:1], 0
  s_load_dwordx2 s[8:9], s[0:1], 32
  s_load_dwordx2 s[10:11], s[0:1], 64
  s_load_dwordx2 s[46:47], s[0:1], 80
  v_lshrrev_b32 v10, 6, v0
  v_and_b32 v0, 255, v0
  v_readfirstlane_b32 s32, v10
  s_nop 3
  s_lshr_b32 s33, s32, 2
  s_and_b32 s36, s32, 3
  s_mul_i32 s14, s33, 33024
  s_add_u32 s14, s14, 31040
  s_and_b32 s12, s2, 7
  s_lshl_b32 s12, s12, 5
  s_lshr_b32 s13, s2, 3
  s_add_u32 s12, s12, s13
  s_lshl_b32 s13, s12, 5
  s_add_u32 s13, s13, 3407872
  s_mul_i32 s15, s2, 50
  v_mov_b32 v24, 0
  v_mov_b32 v25, 0
  v_mov_b32 v26, 0
  v_mov_b32 v27, 0
  s_lshl_b32 s52, s33, 8
  v_add_u32 v29, s52, v0
  v_lshlrev_b32 v28, 4, v29
  ds_write_b128 v28, v[24:27] offset:0
  ds_write_b128 v28, v[24:27] offset:8192
  ds_write_b128 v28, v[24:27] offset:16384
  v_cmp_gt_u32 vcc, 240, v29
  s_mov_b64 exec, vcc
  ds_write_b128 v28, v[24:27] offset:24576
  s_mov_b64 exec, -1
  v_cmp_gt_u32 vcc, 36, v29
  s_mov_b64 exec, vcc
  ds_write_b128 v28, v[24:27] offset:29952
  s_mov_b64 exec, -1
  v_mov_b32 v30, 0x3fff
  v_lshlrev_b32 v28, 2, v29
  v_cmp_gt_u32 vcc, 384, v29
  s_mov_b64 exec, vcc
  ds_write_b32 v28, v30 offset:28416
  s_mov_b64 exec, -1
  s_mov_b32 s41, 0xffff0000
  s_movk_i32 s42, 256
  s_movk_i32 s43, 512
  s_movk_i32 s44, 768
  s_movk_i32 s60, 0x3fff
  s_mov_b32 s61, 0x7ffff
  s_mov_b32 s40, 0
  v_cmp_gt_u32 vcc, 250, v0
  s_mov_b64 s[62:63], vcc
  v_and_b32 v10, 63, v0
  v_lshlrev_b32 v9, 4, v10
  v_lshlrev_b32 v12, 3, v10
  s_mul_i32 s59, s36, 1536
  s_add_u32 s59, s59, 3309568
  s_waitcnt lgkmcnt(0)
  s_barrier
  s_mov_b32 s24, s46
  s_mov_b32 s25, s47
  s_mov_b32 s26, 7553024
  s_mov_b32 s27, 0x20000
  s_cmp_lg_u32 s33, 0
  s_cbranch_scc1 K2_PB0
  v_lshlrev_b32 v33, 13, v0
  v_mov_b32 v36, 0
  v_mov_b32 v37, 0
  v_mov_b32 v38, 0
  v_mov_b32 v39, 0
  v_mov_b32 v40, 0
  v_mov_b32 v41, 0
  v_mov_b32 v42, 0
  v_mov_b32 v43, 0
  s_mov_b64 exec, s[62:63]
  buffer_load_dwordx4 v[36:39], v33, s[24:27], s13 offen
  buffer_load_dwordx4 v[40:43], v33, s[24:27], s13 offen offset:16
  s_mov_b64 exec, -1
K2_COMMON:
  buffer_load_dwordx2 v[16:17], v12, s[24:27], s59 offen offset:0
  buffer_load_dwordx2 v[18:19], v12, s[24:27], s59 offen offset:512
  buffer_load_dwordx2 v[20:21], v12, s[24:27], s59 offen offset:1024
  s_mul_i32 s56, s36, 24576
  s_add_u32 s57, s56, 3227648
  buffer_load_dwordx4 v[224:227], v9, s[24:27], s57 offen offset:0
  buffer_load_dwordx4 v[228:231], v9, s[24:27], s57 offen offset:1024
  buffer_load_dwordx4 v[232:235], v9, s[24:27], s57 offen offset:2048
  buffer_load_dwordx4 v[236:239], v9, s[24:27], s57 offen offset:3072
  s_add_u32 s57, s56, 3231744
  buffer_load_dwordx4 v[240:243], v9, s[24:27], s57 offen offset:0
  buffer_load_dwordx4 v[244:247], v9, s[24:27], s57 offen offset:1024
  buffer_load_dwordx4 v[248:251], v9, s[24:27], s57 offen offset:2048
  buffer_load_dwordx4 v[252:255], v9, s[24:27], s57 offen offset:3072
  s_load_dwordx2 s[54:55], s[8:9], 0
  s_mov_b32 s16, s4
  s_mov_b32 s17, s5
  s_mov_b32 s18, 12800000
  s_mov_b32 s19, 0x20000
  s_mov_b32 s20, s46
  s_mov_b32 s21, s47
  s_mov_b32 s22, 3200000
  s_mov_b32 s23, 0x20000
  s_mov_b32 s28, s6
  s_mov_b32 s29, s7
  s_mov_b32 s30, 75000
  s_mov_b32 s31, 0x20000
  s_mov_b32 s64, s10
  s_mov_b32 s65, s11
  s_mov_b32 s66, 12800000
  s_mov_b32 s67, 0x20000
  v_and_b32 v10, 63, v0
  v_and_b32 v11, 31, v10
  v_lshrrev_b32 v12, 5, v10
  v_and_b32 v13, 7, v11
  v_mul_u32_u24 v1, 1056, v13
  v_lshrrev_b32 v13, 3, v11
  v_lshl_add_u32 v1, v13, 8, v1
  v_and_b32 v13, 1, v13
  v_xor_b32 v13, v13, v12
  v_lshl_add_u32 v1, v13, 4, v1
  v_add_u32 v1, s14, v1
  v_bfe_u32 v13, v10, 2, 2
  v_lshl_add_u32 v14, v12, 2, v13
  v_mul_u32_u24 v2, 3072, v14
  v_xor_b32 v13, s36, v13
  v_lshl_add_u32 v2, v13, 6, v2
  v_and_b32 v13, 1, v10
  v_lshl_add_u32 v2, v13, 5, v2
  v_bfe_u32 v13, v10, 4, 1
  v_lshl_add_u32 v2, v13, 4, v2
  v_bfe_u32 v13, v10, 1, 1
  v_lshl_add_u32 v2, v13, 3, v2
  s_add_u32 s52, s14, 8448
  v_add_u32 v2, s52, v2
  v_lshrrev_b32 v13, 4, v10
  v_and_b32 v14, 15, v10
  v_and_b32 v15, 1, v13
  v_xor_b32 v15, v15, v14
  v_lshlrev_b32 v7, 4, v15
  s_lshl_b32 s52, s36, 1
  s_and_b32 s52, s52, 3
  v_lshrrev_b32 v15, 2, v14
  v_xor_b32 v15, s52, v15
  v_lshlrev_b32 v15, 2, v15
  v_and_b32 v13, 3, v14
  v_add_u32 v15, v15, v13
  v_lshlrev_b32 v8, 4, v15
  v_mov_b32 v96, 0
  v_mov_b32 v97, 0
  v_mov_b32 v98, 0
  v_mov_b32 v99, 0
  v_mov_b32 v100, 0
  v_mov_b32 v101, 0
  v_mov_b32 v102, 0
  v_mov_b32 v103, 0
  v_mov_b32 v104, 0
  v_mov_b32 v105, 0
  v_mov_b32 v106, 0
  v_mov_b32 v107, 0
  v_mov_b32 v108, 0
  v_mov_b32 v109, 0
  v_mov_b32 v110, 0
  v_mov_b32 v111, 0
  v_mov_b32 v112, 0
  v_mov_b32 v113, 0
  v_mov_b32 v114, 0
  v_mov_b32 v115, 0
  v_mov_b32 v116, 0
  v_mov_b32 v117, 0
  v_mov_b32 v118, 0
  v_mov_b32 v119, 0
  v_mov_b32 v120, 0
  v_mov_b32 v121, 0
  v_mov_b32 v122, 0
  v_mov_b32 v123, 0
  v_mov_b32 v124, 0
  v_mov_b32 v125, 0
  v_mov_b32 v126, 0
  v_mov_b32 v127, 0
  v_mov_b32 v128, 0
  v_mov_b32 v129, 0
  v_mov_b32 v130, 0
  v_mov_b32 v131, 0
  v_mov_b32 v132, 0
  v_mov_b32 v133, 0
  v_mov_b32 v134, 0
  v_mov_b32 v135, 0
  v_mov_b32 v136, 0
  v_mov_b32 v137, 0
  v_mov_b32 v138, 0
  v_mov_b32 v139, 0
  v_mov_b32 v140, 0
  v_mov_b32 v141, 0
  v_mov_b32 v142, 0
  v_mov_b32 v143, 0
  v_mov_b32 v144, 0
  v_mov_b32 v145, 0
  v_mov_b32 v146, 0
  v_mov_b32 v147, 0
  v_mov_b32 v148, 0
  v_mov_b32 v149, 0
  v_mov_b32 v150, 0
  v_mov_b32 v151, 0
  v_mov_b32 v152, 0
  v_mov_b32 v153, 0
  v_mov_b32 v154, 0
  v_mov_b32 v155, 0
  v_mov_b32 v156, 0
  v_mov_b32 v157, 0
  v_mov_b32 v158, 0
  v_mov_b32 v159, 0
  s_waitcnt lgkmcnt(0)
  s_lshl_b32 s48, s54, 16
  s_and_b32 s49, s54, s41
  s_lshl_b32 s50, s55, 16
  s_and_b32 s51, s55, s41
  s_cmp_lg_u32 s33, 0
  s_cbranch_scc1 K2_B1
  v_mov_b32 v35, 1
  s_waitcnt vmcnt(11)
  v_and_b32 v44, s61, v36
  v_alignbit_b32 v45, v37, v36, 19
  v_lshrrev_b32 v46, 6, v37
  v_alignbit_b32 v47, v38, v37, 25
  v_lshrrev_b32 v48, 12, v38
  v_alignbit_b32 v49, v39, v38, 31
  v_and_b32 v45, s61, v45
  v_and_b32 v46, s61, v46
  v_and_b32 v47, s61, v47
  v_and_b32 v48, s61, v48
  v_and_b32 v49, s61, v49
  v_lshrrev_b32 v60, 18, v39
  v_and_b32 v56, 7, v60
  v_lshrrev_b32 v60, 3, v60
  v_cmp_eq_u32 vcc, 7, v56
  s_mov_b64 s[68:69], vcc
  v_and_b32 v50, s61, v40
  v_alignbit_b32 v51, v41, v40, 19
  v_lshrrev_b32 v52, 6, v41
  v_alignbit_b32 v53, v42, v41, 25
  v_lshrrev_b32 v54, 12, v42
  v_alignbit_b32 v55, v43, v42, 31
  v_and_b32 v51, s61, v51
  v_and_b32 v52, s61, v52
  v_and_b32 v53, s61, v53
  v_and_b32 v54, s61, v54
  v_and_b32 v55, s61, v55
  v_add_u32 v50, 409600, v50
  v_add_u32 v51, 409600, v51
  v_add_u32 v52, 409600, v52
  v_add_u32 v53, 409600, v53
  v_add_u32 v54, 409600, v54
  v_add_u32 v55, 409600, v55
  v_lshrrev_b32 v61, 18, v43
  v_and_b32 v57, 7, v61
  v_lshrrev_b32 v61, 3, v61
  v_cmp_eq_u32 vcc, 7, v57
  s_mov_b64 s[70:71], vcc
  v_cmp_lt_u32 vcc, 0, v56
  s_andn2_b64 s[84:85], vcc, s[68:69]
  v_lshrrev_b32 v88, 14, v44
  v_lshlrev_b32 v88, 3, v88
  v_cmp_lt_u32 vcc, 1, v56
  s_andn2_b64 s[86:87], vcc, s[68:69]
  v_lshrrev_b32 v89, 14, v45
  v_lshlrev_b32 v89, 3, v89
  v_cmp_lt_u32 vcc, 2, v56
  s_andn2_b64 s[88:89], vcc, s[68:69]
  v_lshrrev_b32 v90, 14, v46
  v_lshlrev_b32 v90, 3, v90
  v_cmp_lt_u32 vcc, 0, v57
  s_andn2_b64 s[90:91], vcc, s[70:71]
  v_lshrrev_b32 v91, 14, v50
  v_lshlrev_b32 v91, 3, v91
  v_cmp_lt_u32 vcc, 1, v57
  s_andn2_b64 s[92:93], vcc, s[70:71]
  v_lshrrev_b32 v92, 14, v51
  v_lshlrev_b32 v92, 3, v92
  v_cmp_lt_u32 vcc, 2, v57
  s_andn2_b64 s[94:95], vcc, s[70:71]
  v_lshrrev_b32 v93, 14, v52
  v_lshlrev_b32 v93, 3, v93
  s_mov_b64 exec, s[84:85]
  ds_add_rtn_u32 v76, v88, v35 offset:29952
  s_mov_b64 exec, s[90:91]
  ds_add_rtn_u32 v82, v91, v35 offset:29952
  s_mov_b64 exec, s[86:87]
  ds_add_rtn_u32 v77, v89, v35 offset:29952
  s_mov_b64 exec, s[92:93]
  ds_add_rtn_u32 v83, v92, v35 offset:29952
  s_mov_b64 exec, s[88:89]
  ds_add_rtn_u32 v78, v90, v35 offset:29952
  s_mov_b64 exec, s[94:95]
  ds_add_rtn_u32 v84, v93, v35 offset:29952
  s_mov_b64 exec, -1
  s_or_b64 s[0:1], s[68:69], s[70:71]
  v_max_u32 v66, v56, v57
  v_cmp_lt_u32 vcc, 3, v66
  s_cmp_lg_u64 vcc, 0
  s_cbranch_scc1 K2_RARE1
K2_RARE1_RET:
  s_waitcnt lgkmcnt(0)
K2_B1:
  s_barrier
  s_cmp_lg_u32 s33, 0
  s_cbranch_scc1 K2_PB2
K2_SCAN:
  v_and_b32 v10, 63, v0
  v_lshlrev_b32 v66, 3, v10
  ds_read_b32 v67, v66 offset:29952
  v_mov_b32 v69, 30496
  ds_read_b32 v70, v69
  s_waitcnt lgkmcnt(0)
  v_mov_b32 v68, v67
  v_readfirstlane_b32 s59, v70
  s_nop 0
  v_add_u32_dpp v68, v68, v68 row_shr:1 row_mask:0xf bank_mask:0xf bound_ctrl:0
  s_nop 1
  v_add_u32_dpp v68, v68, v68 row_shr:2 row_mask:0xf bank_mask:0xf bound_ctrl:0
  s_nop 1
  v_add_u32_dpp v68, v68, v68 row_shr:4 row_mask:0xf bank_mask:0xf bound_ctrl:0
  s_nop 1
  v_add_u32_dpp v68, v68, v68 row_shr:8 row_mask:0xf bank_mask:0xf bound_ctrl:0
  s_nop 1
  v_add_u32_dpp v68, v68, v68 row_bcast:15 row_mask:0xa bank_mask:0xf
  s_nop 1
  v_add_u32_dpp v68, v68, v68 row_bcast:31 row_mask:0xc bank_mask:0xf
  s_nop 1
  v_readlane_b32 s56, v68, 63
  v_sub_u32 v71, v68, v67
  v_add_u32 v72, 31, v68
  v_lshrrev_b32 v72, 5, v72
  v_sub_u32 v73, s56, v68
  v_add_u32 v73, 31, v73
  v_lshrrev_b32 v73, 5, v73
  v_max_u32 v74, v72, v73
  v_min_u32 v75, v72, v73
  v_add_u32 v72, v72, v73
  v_lshlrev_b32 v73, 1, v74
  v_lshl_or_b32 v75, v75, 1, 1
  v_max_u32 v73, v73, v75
  v_cmp_lt_u32 vcc, 12, v72
  v_cmp_lt_u32 s[0:1], 8, v74
  s_or_b64 vcc, vcc, s[0:1]
  v_mov_b32 v75, 99
  s_nop 0
  v_cndmask_b32 v73, v73, v75, vcc
  v_lshl_or_b32 v73, v73, 6, v10
  s_nop 0
  v_readlane_b32 s57, v73, 22
  v_readlane_b32 s58, v73, 23
  v_readlane_b32 s0, v73, 24
  v_readlane_b32 s1, v73, 25
  v_readlane_b32 s52, v73, 26
  s_nop 3
  s_min_u32 s57, s57, s58
  s_min_u32 s0, s0, s1
  s_min_u32 s57, s57, s52
  s_min_u32 s57, s57, s0
  s_and_b32 s58, s57, 63
  s_add_u32 s12, s58, 1
  v_readlane_b32 s58, v68, s58
  s_lshr_b32 s57, s57, 6
  s_nop 2
  s_cmp_ge_u32 s57, 99
  s_cbranch_scc1 K2_SLOW
  s_cmp_lg_u32 s59, 0
  s_cbranch_scc1 K2_SLOW
  s_sub_u32 s57, s56, s58
  s_mov_b32 s56, s58
  s_mov_b32 s53, 1
  s_cmp_lg_u32 s33, 0
  s_cbranch_scc1 K2_FASTB
  v_lshlrev_b32 v71, 2, v71
  v_add_u32 v72, 28416, v71
  s_lshl_b32 s58, s56, 2
  s_add_u32 s58, s58, 29948
  v_sub_u32 v73, s58, v71
  v_cmp_gt_u32 vcc, s12, v10
  v_mov_b32 v74, 4
  v_mov_b32 v75, -4
  v_cndmask_b32 v72, v73, v72, vcc
  v_cndmask_b32 v73, v75, v74, vcc
  ds_write_b64 v66, v[72:73] offset:30528
  s_mov_b64 exec, s[84:85]
  ds_read_b64 v[160:161], v88 offset:30528
  s_mov_b64 exec, s[90:91]
  ds_read_b64 v[166:167], v91 offset:30528
  s_mov_b64 exec, s[86:87]
  ds_read_b64 v[162:163], v89 offset:30528
  s_mov_b64 exec, s[92:93]
  ds_read_b64 v[168:169], v92 offset:30528
  s_mov_b64 exec, s[88:89]
  ds_read_b64 v[164:165], v90 offset:30528
  s_mov_b64 exec, s[94:95]
  ds_read_b64 v[170:171], v93 offset:30528
  s_waitcnt lgkmcnt(0)
  s_mov_b64 exec, s[84:85]
  v_mad_i32_i24 v160, v76, v161, v160
  ds_write_b32 v160, v44
  s_mov_b64 exec, s[90:91]
  v_mad_i32_i24 v166, v82, v167, v166
  ds_write_b32 v166, v50
  s_mov_b64 exec, s[86:87]
  v_mad_i32_i24 v162, v77, v163, v162
  ds_write_b32 v162, v45
  s_mov_b64 exec, s[92:93]
  v_mad_i32_i24 v168, v83, v169, v168
  ds_write_b32 v168, v51
  s_mov_b64 exec, s[88:89]
  v_mad_i32_i24 v164, v78, v165, v164
  ds_write_b32 v164, v46
  s_mov_b64 exec, s[94:95]
  v_mad_i32_i24 v170, v84, v171, v170
  ds_write_b32 v170, v52
  s_mov_b64 exec, -1
  v_max_u32 v66, v56, v57
  v_cmp_lt_u32 vcc, 3, v66
  s_cmp_lg_u64 vcc, 0
  s_cbranch_scc1 K2_RARE2
K2_FASTB:
  s_add_u32 s58, s56, 31
  s_lshr_b32 s58, s58, 5
  s_add_u32 s59, s57, 31
  s_lshr_b32 s59, s59, 5
  s_cmp_gt_u32 s59, s58
  s_cselect_b32 s52, 1, 0
  s_max_u32 s0, s58, s59
  s_min_u32 s1, s58, s59
  s_lshl_b32 s0, s0, 1
  s_lshl_b32 s1, s1, 1
  s_add_u32 s1, s1, 1
  s_max_u32 s39, s0, s1
  s_xor_b32 s52, s52, s33
  s_cmp_eq_u32 s52, 0
  s_cselect_b32 s45, s56, s57
  s_cselect_b32 s37, s58, s59
  s_cselect_b32 s10, 0, s12
  s_cselect_b32 s34, 0, 11
  s_cselect_b32 s46, 1, -1
  s_mul_i32 s6, s46, 1728
  s_mul_i32 s7, s46, 256
  s_mul_i32 s8, s46, 384
  s_mul_i32 s9, s46, 128
  s_sub_u32 s0, 50, s12
  s_cmp_eq_u32 s52, 0
  s_cselect_b32 s11, s12, s0
  s_add_u32 s3, s15, s10
  v_and_b32 v10, 63, v0
  v_and_b32 v11, 31, v10
  v_lshrrev_b32 v12, 5, v10
  v_mul_u32_u24 v13, 27, v12
  v_add_u32 v13, v13, v11
  s_mul_i32 s52, s34, 1728
  v_lshl_add_u32 v3, v13, 4, s52
  s_mul_i32 s52, s34, 256
  s_add_u32 s52, s52, 20736
  v_lshl_add_u32 v4, v11, 3, s52
  s_mul_i32 s52, s34, 384
  s_add_u32 s52, s52, 23808
  v_lshl_add_u32 v5, v12, 4, s52
  v_lshrrev_b32 v13, 4, v10
  s_mul_i32 s52, s34, 128
  s_add_u32 s52, s52, 28416
  s_lshl_b32 s56, s36, 3
  s_add_u32 s52, s52, s56
  v_lshl_add_u32 v6, v13, 5, s52
K2_AFTLIST:
  s_waitcnt vmcnt(0) lgkmcnt(0)
  s_barrier
K2_AFTB2:
  v_lshrrev_b32 v32, 5, v0
  v_mul_i32_i24 v33, s46, v32
  v_add_u32 v33, s34, v33
  v_max_i32 v31, 0, v33
  v_min_i32 v31, 11, v31
  v_and_b32 v30, 31, v0
  v_lshlrev_b32 v29, 2, v30
  v_lshl_add_u32 v29, v31, 7, v29
  ds_read_b32 v34, v29 offset:28416
  s_waitcnt lgkmcnt(0)
  v_and_b32 v35, s60, v34
  v_lshrrev_b32 v36, 14, v34
  v_add_u32 v37, s15, v36
  v_mul_u32_u24 v38, 6, v35
  v_and_b32 v39, 2, v38
  v_and_b32 v38, -4, v38
  v_lshlrev_b32 v39, 3, v39
  buffer_load_dwordx2 v[40:41], v38, s[28:31], 0 offen
  v_mul_u32_u24 v42, 6, v37
  v_and_b32 v43, 2, v42
  v_and_b32 v42, -4, v42
  v_lshlrev_b32 v43, 3, v43
  buffer_load_dwordx2 v[44:45], v42, s[28:31], 0 offen
  v_subrev_u32 v36, s10, v36
  s_cmp_lg_u32 s40, 0
  s_cbranch_scc1 K2_NOW2
  s_cmp_eq_u32 s37, 0
  s_cbranch_scc1 K2_NOW2B
  s_mov_b32 s59, s14
  ds_read_b64 v[66:67], v6
  s_mul_i32 s57, s36, 2112
  s_add_u32 s57, s57, s59
  s_mul_i32 s58, s36, 6144
  s_add_u32 s58, s58, s59
  s_add_u32 s58, s58, 8448
  v_and_b32 v10, 63, v0
  v_lshlrev_b32 v10, 4, v10
  s_lshl_b32 s56, s36, 14
  s_add_u32 s56, s56, 97088
  v_add_u32 v10, s56, v10
  ds_read_b128 v[160:163], v10 offset:0
  ds_read_b128 v[164:167], v10 offset:1024
  ds_read_b128 v[168:171], v10 offset:2048
  ds_read_b128 v[172:175], v10 offset:3072
  ds_read_b128 v[176:179], v10 offset:4096
  ds_read_b128 v[180:183], v10 offset:5120
  ds_read_b128 v[184:187], v10 offset:6144
  ds_read_b128 v[188:191], v10 offset:7168
  ds_read_b128 v[192:195], v10 offset:8192
  ds_read_b128 v[196:199], v10 offset:9216
  ds_read_b128 v[200:203], v10 offset:10240
  ds_read_b128 v[204:207], v10 offset:11264
  ds_read_b128 v[208:211], v10 offset:12288
  ds_read_b128 v[212:215], v10 offset:13312
  s_waitcnt lgkmcnt(14)
  v_and_b32 v66, s60, v66
  v_and_b32 v67, s60, v67
  v_lshl_add_u32 v68, v66, 8, v7
  v_lshl_add_u32 v69, v67, 8, v7
  v_lshl_add_u32 v70, v66, 10, v8
  v_lshl_add_u32 v71, v67, 10, v8
  v_xor_b32 v71, 64, v71
  v_add_u32 v6, s9, v6
  s_mov_b32 m0, s57
  s_nop 0
  buffer_load_dwordx4 v68, s[20:23], 0 offen  lds
  s_add_u32 m0, s57, 1056
  s_nop 0
  buffer_load_dwordx4 v69, s[20:23], 0 offen  lds
  s_add_u32 m0, s58, 0
  s_nop 0
  buffer_load_dwordx4 v70, s[16:19], s42 offen  lds
  s_add_u32 m0, s58, 1024
  s_nop 0
  buffer_load_dwordx4 v70, s[16:19], s43 offen  lds
  s_add_u32 m0, s58, 2048
  s_nop 0
  buffer_load_dwordx4 v70, s[16:19], s44 offen  lds
  s_add_u32 m0, s58, 3072
  s_nop 0
  buffer_load_dwordx4 v71, s[16:19], s42 offen  lds
  s_add_u32 m0, s58, 4096
  s_nop 0
  buffer_load_dwordx4 v71, s[16:19], s43 offen  lds
  s_add_u32 m0, s58, 5120
  s_nop 0
  buffer_load_dwordx4 v71, s[16:19], s44 offen  lds
  ds_read_b128 v[216:219], v10 offset:14336
  ds_read_b128 v[220:223], v10 offset:15360
K2_I0DONE:
  s_waitcnt lgkmcnt(0)
  s_cmp_eq_u32 s33, 0
  s_cbranch_scc1 K2_NOI0B
  s_barrier
K2_NOI0B:
  s_waitcnt vmcnt(8)
  v_alignbit_b32 v52, v41, v40, v39
  v_lshrrev_b32 v48, v39, v41
  v_lshlrev_b32 v46, 16, v52
  v_and_b32 v47, s41, v52
  v_lshlrev_b32 v48, 16, v48
  v_alignbit_b32 v52, v45, v44, v43
  v_lshrrev_b32 v51, v43, v45
  v_lshlrev_b32 v49, 16, v52
  v_and_b32 v50, s41, v52
  v_lshlrev_b32 v51, 16, v51
  v_sub_f32 v46, v46, v49
  v_sub_f32 v47, v47, v50
  v_sub_f32 v48, v48, v51
  v_cvt_pk_bf16_f32 v52, v46, v47
  v_cvt_pk_bf16_f32 v53, v48, v48
  v_lshlrev_b32 v46, 16, v52
  v_and_b32 v47, s41, v52
  v_lshlrev_b32 v48, 16, v53
  v_mul_f32 v49, v46, v46
  v_mul_f32 v50, v47, v47
  v_mul_f32 v51, v48, v48
  v_cvt_pk_bf16_f32 v52, v49, v50
  v_cvt_pk_bf16_f32 v53, v51, v51
  v_lshlrev_b32 v49, 16, v52
  v_and_b32 v50, s41, v52
  v_lshlrev_b32 v51, 16, v53
  v_add_f32 v49, v49, v50
  v_add_f32 v49, v49, v51
  v_cvt_pk_bf16_f32 v52, v49, v49
  v_lshlrev_b32 v49, 16, v52
  v_add_f32 v49, 0x322bcc77, v49
  v_cvt_pk_bf16_f32 v52, v49, v49
  v_lshlrev_b32 v49, 16, v52
  v_sqrt_f32 v49, v49
  s_nop 0
  v_cvt_pk_bf16_f32 v52, v49, v49
  v_lshlrev_b32 v49, 16, v52
  v_rcp_f32 v50, v49
  v_mul_f32 v52, s48, v49
  v_mul_f32 v53, s49, v49
  v_mul_f32 v54, s50, v49
  v_mul_f32 v55, s51, v49
  v_cvt_pk_bf16_f32 v56, v52, v53
  v_cvt_pk_bf16_f32 v57, v54, v55
  v_lshlrev_b32 v52, 16, v56
  v_and_b32 v53, s41, v56
  v_lshlrev_b32 v54, 16, v57
  v_and_b32 v55, s41, v57
  v_mul_f32 v52, 0.15915494, v52
  v_mul_f32 v53, 0.15915494, v53
  v_mul_f32 v54, 0.15915494, v54
  v_mul_f32 v55, 0.15915494, v55
  v_fract_f32 v52, v52
  v_fract_f32 v53, v53
  v_fract_f32 v54, v54
  v_fract_f32 v55, v55
  v_sin_f32 v52, v52
  v_sin_f32 v53, v53
  v_sin_f32 v54, v54
  v_sin_f32 v55, v55
  v_mul_f32 v58, 0x40490fdb, v49
  v_cvt_pk_bf16_f32 v59, v58, v58
  v_lshlrev_b32 v58, 16, v59
  v_mul_f32 v58, 0x3e4ccccd, v58
  v_cvt_pk_bf16_f32 v59, v58, v58
  v_lshlrev_b32 v58, 16, v59
  v_mul_f32 v58, 0.15915494, v58
  v_cos_f32 v58, v58
  v_cvt_pk_bf16_f32 v56, v52, v53
  v_cvt_pk_bf16_f32 v57, v54, v55
  v_lshlrev_b32 v52, 16, v56
  v_and_b32 v53, s41, v56
  v_lshlrev_b32 v54, 16, v57
  v_and_b32 v55, s41, v57
  v_mul_f32 v52, v52, v50
  v_mul_f32 v53, v53, v50
  v_mul_f32 v54, v54, v50
  v_mul_f32 v55, v55, v50
  v_cvt_pk_bf16_f32 v56, v52, v53
  v_cvt_pk_bf16_f32 v57, v54, v55
  v_cvt_pk_bf16_f32 v59, v58, v58
  v_lshlrev_b32 v58, 16, v59
  v_add_f32 v58, 1.0, v58
  v_cvt_pk_bf16_f32 v59, v58, v58
  v_lshlrev_b32 v58, 16, v59
  v_mul_f32 v58, 0.5, v58
  v_cvt_pk_bf16_f32 v59, v58, v58
  v_mov_b32 v60, 0x40a00000
  v_cmp_lt_f32 vcc, v49, v60
  v_mul_f32 v46, v46, v50
  v_mul_f32 v47, v47, v50
  v_mul_f32 v48, v48, v50
  v_cndmask_b32 v59, 0, v59, vcc
  v_cvt_pk_bf16_f32 v60, v46, v47
  v_cvt_pk_bf16_f32 v61, v48, v48
  v_lshlrev_b32 v46, 16, v60
  v_and_b32 v47, s41, v60
  v_lshlrev_b32 v48, 16, v61
  v_lshlrev_b32 v62, 3, v30
  v_lshl_add_u32 v62, v31, 8, v62
  v_mul_u32_u24 v63, 1728, v31
  v_lshrrev_b32 v64, 4, v30
  v_bfe_u32 v65, v30, 2, 1
  v_lshl_add_u32 v64, v64, 1, v65
  v_mul_u32_u24 v64, 27, v64
  v_add_u32 v64, v64, v36
  v_lshl_add_u32 v63, v64, 4, v63
  v_bfe_u32 v64, v30, 3, 1
  v_lshl_add_u32 v63, v64, 3, v63
  v_and_b32 v64, 3, v30
  v_lshl_add_u32 v63, v64, 1, v63
  v_mul_u32_u24 v64, 384, v31
  v_lshl_add_u32 v64, v30, 2, v64
  v_cmp_gt_u32 vcc, s37, v32
  v_cmp_ne_u32 s[0:1], s60, v35
  s_and_b64 exec, vcc, s[0:1]
  ds_write_b64 v62, v[56:57] offset:20736
  ds_write_b16 v63, v59 offset:0
  ds_write_b32 v64, v46 offset:23808
  ds_write_b32 v64, v47 offset:23936
  ds_write_b32 v64, v48 offset:24064
  s_mov_b64 exec, -1
  s_mov_b32 s38, 0
  s_mov_b32 s47, 66048
  s_mov_b32 s35, 0
  s_mov_b32 s35, s33
  s_cmp_eq_u32 s37, 0
  s_cbranch_scc1 K2_LOOPEND
K2_LOOP:
  s_waitcnt vmcnt(6) lgkmcnt(0)
  s_barrier
  s_add_u32 s46, s38, 1
  s_and_b32 s59, s46, 1
  s_mul_i32 s59, s59, 66048
  s_add_u32 s59, s59, s14
  s_cmp_lg_u32 s46, s37
  s_cbranch_scc1 K2_PA_G
  s_cmp_lg_u32 s53, 0
  s_cbranch_scc1 K2_PA_R
K2_PA_G:
  ds_read_b64 v[22:23], v4
  ds_read_b128 v[24:27], v1
  ds_read_b128 v[28:31], v1 offset:32
  ds_read_b64 v[10:11], v6
  s_mul_i32 s57, s36, 2112
  s_add_u32 s57, s57, s59
  s_mul_i32 s58, s36, 6144
  s_add_u32 s58, s58, s59
  s_add_u32 s58, s58, 8448
  s_waitcnt lgkmcnt(1)
  v_mfma_f32_32x32x8_bf16 v[32:47], v[22:23], v[16:17], 0
  v_mfma_f32_32x32x16_bf16 v[48:63], v[24:27], v[160:163], 0
  v_mfma_f32_32x32x16_bf16 v[64:79], v[24:27], v[192:195], 0
  v_mfma_f32_32x32x16_bf16 v[80:95], v[24:27], v[224:227], 0
  ds_read_b128 v[24:27], v1 offset:64
  s_waitcnt lgkmcnt(1)
  v_and_b32 v10, s60, v10
  v_and_b32 v11, s60, v11
  v_lshl_add_u32 v12, v10, 8, v7
  v_lshl_add_u32 v13, v11, 8, v7
  v_lshl_add_u32 v14, v10, 10, v8
  v_lshl_add_u32 v15, v11, 10, v8
  v_xor_b32 v15, 64, v15
  v_add_u32 v6, s9, v6
  v_mfma_f32_32x32x16_bf16 v[48:63], v[28:31], v[164:167], v[48:63]
  v_mfma_f32_32x32x16_bf16 v[64:79], v[28:31], v[196:199], v[64:79]
  v_mfma_f32_32x32x16_bf16 v[80:95], v[28:31], v[228:231], v[80:95]
  ds_read_b128 v[28:31], v1 offset:96
  s_mov_b32 m0, s57
  s_nop 0
  buffer_load_dwordx4 v12, s[20:23], 0 offen  lds
  s_waitcnt lgkmcnt(1)
  v_mfma_f32_32x32x16_bf16 v[48:63], v[24:27], v[168:171], v[48:63]
  v_mfma_f32_32x32x16_bf16 v[64:79], v[24:27], v[200:203], v[64:79]
  v_mfma_f32_32x32x16_bf16 v[80:95], v[24:27], v[232:235], v[80:95]
  ds_read_b128 v[24:27], v1 offset:128
  s_add_u32 m0, s57, 1056
  s_nop 0
  buffer_load_dwordx4 v13, s[20:23], 0 offen  lds
  s_waitcnt lgkmcnt(1)
  v_mfma_f32_32x32x16_bf16 v[48:63], v[28:31], v[172:175], v[48:63]
  v_mfma_f32_32x32x16_bf16 v[64:79], v[28:31], v[204:207], v[64:79]
  v_mfma_f32_32x32x16_bf16 v[80:95], v[28:31], v[236:239], v[80:95]
  ds_read_b128 v[28:31], v1 offset:160
  s_add_u32 m0, s58, 0
  s_nop 0
  buffer_load_dwordx4 v14, s[16:19], s42 offen  lds
  s_waitcnt lgkmcnt(1)
  v_mfma_f32_32x32x16_bf16 v[48:63], v[24:27], v[176:179], v[48:63]
  v_mfma_f32_32x32x16_bf16 v[64:79], v[24:27], v[208:211], v[64:79]
  v_mfma_f32_32x32x16_bf16 v[80:95], v[24:27], v[240:243], v[80:95]
  ds_read_b128 v[24:27], v1 offset:192
  s_add_u32 m0, s58, 1024
  s_nop 0
  buffer_load_dwordx4 v14, s[16:19], s43 offen  lds
  s_waitcnt lgkmcnt(1)
  v_mfma_f32_32x32x16_bf16 v[48:63], v[28:31], v[180:183], v[48:63]
  v_mfma_f32_32x32x16_bf16 v[64:79], v[28:31], v[212:215], v[64:79]
  v_mfma_f32_32x32x16_bf16 v[80:95], v[28:31], v[244:247], v[80:95]
  ds_read_b128 v[28:31], v1 offset:224
  s_add_u32 m0, s58, 2048
  s_nop 0
  buffer_load_dwordx4 v14, s[16:19], s44 offen  lds
  s_waitcnt lgkmcnt(1)
  v_mfma_f32_32x32x16_bf16 v[48:63], v[24:27], v[184:187], v[48:63]
  v_mfma_f32_32x32x16_bf16 v[64:79], v[24:27], v[216:219], v[64:79]
  v_mfma_f32_32x32x16_bf16 v[80:95], v[24:27], v[248:251], v[80:95]
  s_add_u32 m0, s58, 3072
  s_nop 0
  buffer_load_dwordx4 v15, s[16:19], s42 offen  lds
  s_waitcnt lgkmcnt(0)
  v_mfma_f32_32x32x16_bf16 v[48:63], v[28:31], v[188:191], v[48:63]
  v_mfma_f32_32x32x16_bf16 v[64:79], v[28:31], v[220:223], v[64:79]
  v_mfma_f32_32x32x16_bf16 v[80:95], v[28:31], v[252:255], v[80:95]
  s_add_u32 m0, s58, 4096
  s_nop 0
  buffer_load_dwordx4 v15, s[16:19], s43 offen  lds
  s_add_u32 m0, s58, 5120
  s_nop 0
  buffer_load_dwordx4 v15, s[16:19], s44 offen  lds
K2_MID:
  ds_read_b128 v[24:27], v3
  ds_read_b128 v[28:31], v3 offset:864
  v_add_u32 v1, s47, v1
  v_add_u32 v3, s6, v3
  s_nop 7
  v_mul_f32 v48, v48, v32
  v_mul_f32 v49, v49, v33
  v_mul_f32 v50, v50, v34
  v_mul_f32 v51, v51, v35
  v_mul_f32 v52, v52, v36
  v_mul_f32 v53, v53, v37
  v_mul_f32 v54, v54, v38
  v_mul_f32 v55, v55, v39
  v_mul_f32 v56, v56, v40
  v_mul_f32 v57, v57, v41
  v_mul_f32 v58, v58, v42
  v_mul_f32 v59, v59, v43
  v_mul_f32 v60, v60, v44
  v_mul_f32 v61, v61, v45
  v_mul_f32 v62, v62, v46
  v_mul_f32 v63, v63, v47
  v_mfma_f32_32x32x8_bf16 v[32:47], v[22:23], v[20:21], 0
  v_cvt_pk_bf16_f32 v48, v48, v49
  v_cvt_pk_bf16_f32 v49, v50, v51
  v_cvt_pk_bf16_f32 v50, v52, v53
  v_cvt_pk_bf16_f32 v51, v54, v55
  v_cvt_pk_bf16_f32 v52, v56, v57
  v_cvt_pk_bf16_f32 v53, v58, v59
  v_cvt_pk_bf16_f32 v54, v60, v61
  v_cvt_pk_bf16_f32 v55, v62, v63
  s_waitcnt lgkmcnt(0)
  s_nop 0
  v_mfma_f32_32x32x16_bf16 v[96:111], v[48:51], v[24:27], v[96:111]
  v_mfma_f32_32x32x16_bf16 v[96:111], v[52:55], v[28:31], v[96:111]
  s_waitcnt vmcnt(8)
  s_barrier
  s_setprio 1
  ds_read_b64_tr_b16 v[10:11], v2 offset:0
  ds_read_b128 v[60:63], v5 offset:0
  v_mul_f32 v80, v80, v32
  v_mul_f32 v81, v81, v33
  v_mul_f32 v82, v82, v34
  v_mul_f32 v83, v83, v35
  v_mul_f32 v84, v84, v36
  v_mul_f32 v85, v85, v37
  v_mul_f32 v86, v86, v38
  v_mul_f32 v87, v87, v39
  v_mul_f32 v88, v88, v40
  v_mul_f32 v89, v89, v41
  v_mul_f32 v90, v90, v42
  v_mul_f32 v91, v91, v43
  v_mul_f32 v92, v92, v44
  v_mul_f32 v93, v93, v45
  v_mul_f32 v94, v94, v46
  v_mul_f32 v95, v95, v47
  v_mfma_f32_32x32x8_bf16 v[32:47], v[22:23], v[18:19], 0
  s_waitcnt lgkmcnt(0)
  v_lshlrev_b32 v56, 16, v10
  v_and_b32 v57, s41, v10
  v_lshlrev_b32 v58, 16, v11
  v_and_b32 v59, s41, v11
  v_mul_f32 v60, v80, v60
  v_mul_f32 v61, v81, v61
  v_mul_f32 v62, v82, v62
  v_mul_f32 v63, v83, v63
  v_add_u32 v4, s7, v4
  s_nop 1
  v_mul_f32 v64, v64, v32
  v_mul_f32 v65, v65, v33
  v_mul_f32 v66, v66, v34
  v_mul_f32 v67, v67, v35
  v_mul_f32 v68, v68, v36
  v_mul_f32 v69, v69, v37
  v_mul_f32 v70, v70, v38
  v_mul_f32 v71, v71, v39
  v_mul_f32 v72, v72, v40
  v_mul_f32 v73, v73, v41
  v_mul_f32 v74, v74, v42
  v_mul_f32 v75, v75, v43
  v_mul_f32 v76, v76, v44
  v_mul_f32 v77, v77, v45
  v_mul_f32 v78, v78, v46
  v_mul_f32 v79, v79, v47
  ds_read_b64_tr_b16 v[32:33], v2 offset:256
  ds_read_b128 v[34:37], v5 offset:32
  ds_read_b64_tr_b16 v[40:41], v2 offset:512
  ds_read_b128 v[42:45], v5 offset:64
  v_fma_f32 v56, v56, v64, v60
  v_fma_f32 v57, v57, v65, v61
  v_fma_f32 v58, v58, v66, v62
  v_fma_f32 v59, v59, v67, v63
  v_cvt_pk_bf16_f32 v48, v56, v57
  v_cvt_pk_bf16_f32 v49, v58, v59
  ds_read_b64_tr_b16 v[10:11], v2 offset:768
  ds_read_b128 v[60:63], v5 offset:96
  s_waitcnt lgkmcnt(4)
  v_lshlrev_b32 v56, 16, v32
  v_and_b32 v57, s41, v32
  v_lshlrev_b32 v58, 16, v33
  v_and_b32 v59, s41, v33
  v_mul_f32 v56, v56, v68
  v_mul_f32 v57, v57, v69
  v_mul_f32 v58, v58, v70
  v_mul_f32 v59, v59, v71
  v_fmac_f32 v56, v84, v34
  v_fmac_f32 v57, v85, v35
  v_fmac_f32 v58, v86, v36
  v_fmac_f32 v59, v87, v37
  v_cvt_pk_bf16_f32 v50, v56, v57
  v_cvt_pk_bf16_f32 v51, v58, v59
  ds_read_b64_tr_b16 v[32:33], v2 offset:1024
  ds_read_b128 v[34:37], v5 offset:128
  v_mfma_f32_32x32x16_bf16 v[112:127], v[48:51], v[24:27], v[112:127]
  s_waitcnt lgkmcnt(4)
  v_lshlrev_b32 v56, 16, v40
  v_and_b32 v57, s41, v40
  v_lshlrev_b32 v58, 16, v41
  v_and_b32 v59, s41, v41
  v_mul_f32 v56, v56, v72
  v_mul_f32 v57, v57, v73
  v_mul_f32 v58, v58, v74
  v_mul_f32 v59, v59, v75
  v_fmac_f32 v56, v88, v42
  v_fmac_f32 v57, v89, v43
  v_fmac_f32 v58, v90, v44
  v_fmac_f32 v59, v91, v45
  v_cvt_pk_bf16_f32 v52, v56, v57
  v_cvt_pk_bf16_f32 v53, v58, v59
  ds_read_b64_tr_b16 v[40:41], v2 offset:1280
  ds_read_b128 v[42:45], v5 offset:160
  s_waitcnt lgkmcnt(4)
  v_lshlrev_b32 v56, 16, v10
  v_and_b32 v57, s41, v10
  v_lshlrev_b32 v58, 16, v11
  v_and_b32 v59, s41, v11
  v_mul_f32 v56, v56, v76
  v_mul_f32 v57, v57, v77
  v_mul_f32 v58, v58, v78
  v_mul_f32 v59, v59, v79
  v_fmac_f32 v56, v92, v60
  v_fmac_f32 v57, v93, v61
  v_fmac_f32 v58, v94, v62
  v_fmac_f32 v59, v95, v63
  v_cvt_pk_bf16_f32 v54, v56, v57
  v_cvt_pk_bf16_f32 v55, v58, v59
  ds_read_b64_tr_b16 v[10:11], v2 offset:1536
  ds_read_b128 v[60:63], v5 offset:192
  v_mfma_f32_32x32x16_bf16 v[112:127], v[52:55], v[28:31], v[112:127]
  s_waitcnt lgkmcnt(4)
  v_lshlrev_b32 v56, 16, v32
  v_and_b32 v57, s41, v32
  v_lshlrev_b32 v58, 16, v33
  v_and_b32 v59, s41, v33
  v_mul_f32 v56, v56, v64
  v_mul_f32 v57, v57, v65
  v_mul_f32 v58, v58, v66
  v_mul_f32 v59, v59, v67
  v_fmac_f32 v56, v80, v34
  v_fmac_f32 v57, v81, v35
  v_fmac_f32 v58, v82, v36
  v_fmac_f32 v59, v83, v37
  v_cvt_pk_bf16_f32 v48, v56, v57
  v_cvt_pk_bf16_f32 v49, v58, v59
  ds_read_b64_tr_b16 v[32:33], v2 offset:1792
  ds_read_b128 v[34:37], v5 offset:224
  s_waitcnt lgkmcnt(4)
  v_lshlrev_b32 v56, 16, v40
  v_and_b32 v57, s41, v40
  v_lshlrev_b32 v58, 16, v41
  v_and_b32 v59, s41, v41
  v_mul_f32 v56, v56, v68
  v_mul_f32 v57, v57, v69
  v_mul_f32 v58, v58, v70
  v_mul_f32 v59, v59, v71
  v_fmac_f32 v56, v84, v42
  v_fmac_f32 v57, v85, v43
  v_fmac_f32 v58, v86, v44
  v_fmac_f32 v59, v87, v45
  v_cvt_pk_bf16_f32 v50, v56, v57
  v_cvt_pk_bf16_f32 v51, v58, v59
  ds_read_b64_tr_b16 v[40:41], v2 offset:2048
  ds_read_b128 v[42:45], v5 offset:256
  v_mfma_f32_32x32x16_bf16 v[128:143], v[48:51], v[24:27], v[128:143]
  s_waitcnt lgkmcnt(4)
  v_lshlrev_b32 v56, 16, v10
  v_and_b32 v57, s41, v10
  v_lshlrev_b32 v58, 16, v11
  v_and_b32 v59, s41, v11
  v_mul_f32 v56, v56, v72
  v_mul_f32 v57, v57, v73
  v_mul_f32 v58, v58, v74
  v_mul_f32 v59, v59, v75
  v_fmac_f32 v56, v88, v60
  v_fmac_f32 v57, v89, v61
  v_fmac_f32 v58, v90, v62
  v_fmac_f32 v59, v91, v63
  v_cvt_pk_bf16_f32 v52, v56, v57
  v_cvt_pk_bf16_f32 v53, v58, v59
  ds_read_b64_tr_b16 v[10:11], v2 offset:2304
  ds_read_b128 v[60:63], v5 offset:288
  s_waitcnt lgkmcnt(4)
  v_lshlrev_b32 v56, 16, v32
  v_and_b32 v57, s41, v32
  v_lshlrev_b32 v58, 16, v33
  v_and_b32 v59, s41, v33
  v_mul_f32 v56, v56, v76
  v_mul_f32 v57, v57, v77
  v_mul_f32 v58, v58, v78
  v_mul_f32 v59, v59, v79
  v_fmac_f32 v56, v92, v34
  v_fmac_f32 v57, v93, v35
  v_fmac_f32 v58, v94, v36
  v_fmac_f32 v59, v95, v37
  v_cvt_pk_bf16_f32 v54, v56, v57
  v_cvt_pk_bf16_f32 v55, v58, v59
  ds_read_b64_tr_b16 v[32:33], v2 offset:2560
  ds_read_b128 v[34:37], v5 offset:320
  v_mfma_f32_32x32x16_bf16 v[128:143], v[52:55], v[28:31], v[128:143]
  s_waitcnt lgkmcnt(4)
  v_lshlrev_b32 v56, 16, v40
  v_and_b32 v57, s41, v40
  v_lshlrev_b32 v58, 16, v41
  v_and_b32 v59, s41, v41
  v_mul_f32 v56, v56, v64
  v_mul_f32 v57, v57, v65
  v_mul_f32 v58, v58, v66
  v_mul_f32 v59, v59, v67
  v_fmac_f32 v56, v80, v42
  v_fmac_f32 v57, v81, v43
  v_fmac_f32 v58, v82, v44
  v_fmac_f32 v59, v83, v45
  v_cvt_pk_bf16_f32 v48, v56, v57
  v_cvt_pk_bf16_f32 v49, v58, v59
  ds_read_b64_tr_b16 v[40:41], v2 offset:2816
  ds_read_b128 v[42:45], v5 offset:352
  s_waitcnt lgkmcnt(4)
  v_lshlrev_b32 v56, 16, v10
  v_and_b32 v57, s41, v10
  v_lshlrev_b32 v58, 16, v11
  v_and_b32 v59, s41, v11
  v_mul_f32 v56, v56, v68
  v_mul_f32 v57, v57, v69
  v_mul_f32 v58, v58, v70
  v_mul_f32 v59, v59, v71
  v_fmac_f32 v56, v84, v60
  v_fmac_f32 v57, v85, v61
  v_fmac_f32 v58, v86, v62
  v_fmac_f32 v59, v87, v63
  v_cvt_pk_bf16_f32 v50, v56, v57
  v_cvt_pk_bf16_f32 v51, v58, v59
  s_nop 1
  v_mfma_f32_32x32x16_bf16 v[144:159], v[48:51], v[24:27], v[144:159]
  s_waitcnt lgkmcnt(2)
  v_lshlrev_b32 v56, 16, v32
  v_and_b32 v57, s41, v32
  v_lshlrev_b32 v58, 16, v33
  v_and_b32 v59, s41, v33
  v_mul_f32 v56, v56, v72
  v_mul_f32 v57, v57, v73
  v_mul_f32 v58, v58, v74
  v_mul_f32 v59, v59, v75
  v_fmac_f32 v56, v88, v34
  v_fmac_f32 v57, v89, v35
  v_fmac_f32 v58, v90, v36
  v_fmac_f32 v59, v91, v37
  v_cvt_pk_bf16_f32 v52, v56, v57
  v_cvt_pk_bf16_f32 v53, v58, v59
  s_waitcnt lgkmcnt(0)
  v_lshlrev_b32 v56, 16, v40
  v_and_b32 v57, s41, v40
  v_lshlrev_b32 v58, 16, v41
  v_and_b32 v59, s41, v41
  v_mul_f32 v56, v56, v76
  v_mul_f32 v57, v57, v77
  v_mul_f32 v58, v58, v78
  v_mul_f32 v59, v59, v79
  v_fmac_f32 v56, v92, v42
  v_fmac_f32 v57, v93, v43
  v_fmac_f32 v58, v94, v44
  v_fmac_f32 v59, v95, v45
  v_cvt_pk_bf16_f32 v54, v56, v57
  v_cvt_pk_bf16_f32 v55, v58, v59
  s_nop 1
  v_mfma_f32_32x32x16_bf16 v[144:159], v[52:55], v[28:31], v[144:159]
  v_add_u32 v2, s47, v2
  v_add_u32 v5, s8, v5
  s_sub_u32 s47, 0, s47
  s_setprio 0
  s_add_u32 s35, s35, 2
  s_add_u32 s38, s38, 1
  s_cmp_lt_u32 s38, s37
  s_cbranch_scc1 K2_LOOP
K2_LOOPEND:
  s_cmp_eq_u32 s53, 0
  s_cbranch_scc1 K2_PAD
K2_EPI:
  s_and_b32 s56, s37, 1
  s_mul_i32 s57, s56, 66048
  s_sub_u32 s58, 66048, s57
  s_add_u32 s57, s57, s14
  s_add_u32 s58, s58, s14
  v_and_b32 v10, 63, v0
  v_and_b32 v11, 31, v10
  v_lshrrev_b32 v12, 5, v10
  v_lshlrev_b32 v13, 3, v12
  v_sub_u32 v13, v11, v13
  v_and_b32 v14, 1, v11
  v_lshlrev_b32 v14, 4, v14
  v_mov_b32 v15, 0x3f80
  v_lshlrev_b32 v14, v14, v15
  v_subrev_u32 v15, 0, v13
  v_lshrrev_b32 v15, 1, v15
  v_cmp_eq_u32 vcc, 0, v15
  s_nop 1
  v_cndmask_b32 v24, 0, v14, vcc
  v_cmp_eq_u32 vcc, 1, v15
  s_nop 1
  v_cndmask_b32 v25, 0, v14, vcc
  v_cmp_eq_u32 vcc, 2, v15
  s_nop 1
  v_cndmask_b32 v26, 0, v14, vcc
  v_cmp_eq_u32 vcc, 3, v15
  s_nop 1
  v_cndmask_b32 v27, 0, v14, vcc
  v_subrev_u32 v15, 16, v13
  v_lshrrev_b32 v15, 1, v15
  v_cmp_eq_u32 vcc, 0, v15
  s_nop 1
  v_cndmask_b32 v28, 0, v14, vcc
  v_cmp_eq_u32 vcc, 1, v15
  s_nop 1
  v_cndmask_b32 v29, 0, v14, vcc
  v_cmp_eq_u32 vcc, 2, v15
  s_nop 1
  v_cndmask_b32 v30, 0, v14, vcc
  v_cmp_eq_u32 vcc, 3, v15
  s_nop 1
  v_cndmask_b32 v31, 0, v14, vcc
  v_bfe_u32 v14, v10, 2, 2
  v_lshl_add_u32 v13, v12, 3, v14
  v_lshlrev_b32 v13, 10, v13
  v_xor_b32 v14, s36, v14
  v_lshl_add_u32 v13, v14, 6, v13
  v_and_b32 v14, 1, v10
  v_lshl_add_u32 v13, v14, 5, v13
  v_bfe_u32 v14, v10, 4, 1
  v_lshl_add_u32 v13, v14, 4, v13
  v_bfe_u32 v14, v10, 1, 1
  v_lshl_add_u32 v13, v14, 3, v13
  v_add_u32 v13, s57, v13
  v_mul_u32_u24 v14, 1040, v11
  v_lshl_add_u32 v14, v12, 5, v14
  s_lshl_b32 s59, s36, 6
  s_add_u32 s59, s59, s58
  v_add_u32 v14, s59, v14
  v_cmp_gt_u32 s[70:71], s11, v11
  s_waitcnt vmcnt(0) lgkmcnt(0)
  s_barrier
  ds_read_b64_tr_b16 v[32:33], v13 offset:0
  ds_read_b64_tr_b16 v[34:35], v13 offset:4096
  ds_read_b64_tr_b16 v[36:37], v13 offset:16384
  ds_read_b64_tr_b16 v[38:39], v13 offset:20480
  ds_read_b64_tr_b16 v[40:41], v13 offset:256
  ds_read_b64_tr_b16 v[42:43], v13 offset:4352
  ds_read_b64_tr_b16 v[44:45], v13 offset:16640
  ds_read_b64_tr_b16 v[46:47], v13 offset:20736
  ds_read_b64_tr_b16 v[48:49], v13 offset:512
  ds_read_b64_tr_b16 v[50:51], v13 offset:4608
  ds_read_b64_tr_b16 v[52:53], v13 offset:16896
  ds_read_b64_tr_b16 v[54:55], v13 offset:20992
  s_waitcnt lgkmcnt(10)
  v_mfma_f32_32x32x16_bf16 v[96:111], v[32:35], v[24:27], v[96:111]
  s_waitcnt lgkmcnt(8)
  v_mfma_f32_32x32x16_bf16 v[96:111], v[36:39], v[28:31], v[96:111]
  ds_read_b64_tr_b16 v[56:57], v13 offset:768
  ds_read_b64_tr_b16 v[58:59], v13 offset:4864
  ds_read_b64_tr_b16 v[60:61], v13 offset:17152
  ds_read_b64_tr_b16 v[62:63], v13 offset:21248
  s_waitcnt lgkmcnt(10)
  v_mfma_f32_32x32x16_bf16 v[112:127], v[40:43], v[24:27], v[112:127]
  s_waitcnt lgkmcnt(8)
  v_mfma_f32_32x32x16_bf16 v[112:127], v[44:47], v[28:31], v[112:127]
  s_waitcnt lgkmcnt(6)
  v_mfma_f32_32x32x16_bf16 v[128:143], v[48:51], v[24:27], v[128:143]
  s_waitcnt lgkmcnt(4)
  v_mfma_f32_32x32x16_bf16 v[128:143], v[52:55], v[28:31], v[128:143]
  s_waitcnt lgkmcnt(2)
  v_mfma_f32_32x32x16_bf16 v[144:159], v[56:59], v[24:27], v[144:159]
  s_waitcnt lgkmcnt(0)
  v_mfma_f32_32x32x16_bf16 v[144:159], v[60:63], v[28:31], v[144:159]
  s_nop 7
  s_nop 2
  v_cvt_pk_bf16_f32 v64, v96, v97
  v_cvt_pk_bf16_f32 v65, v98, v99
  v_cvt_pk_bf16_f32 v66, v100, v101
  v_cvt_pk_bf16_f32 v67, v102, v103
  v_cvt_pk_bf16_f32 v68, v104, v105
  v_cvt_pk_bf16_f32 v69, v106, v107
  v_cvt_pk_bf16_f32 v70, v108, v109
  v_cvt_pk_bf16_f32 v71, v110, v111
  s_mov_b64 exec, s[70:71]
  ds_write_b128 v14, v[64:67] offset:0
  ds_write_b128 v14, v[68:71] offset:16
  s_mov_b64 exec, -1
  v_cvt_pk_bf16_f32 v72, v112, v113
  v_cvt_pk_bf16_f32 v73, v114, v115
  v_cvt_pk_bf16_f32 v74, v116, v117
  v_cvt_pk_bf16_f32 v75, v118, v119
  v_cvt_pk_bf16_f32 v76, v120, v121
  v_cvt_pk_bf16_f32 v77, v122, v123
  v_cvt_pk_bf16_f32 v78, v124, v125
  v_cvt_pk_bf16_f32 v79, v126, v127
  s_mov_b64 exec, s[70:71]
  ds_write_b128 v14, v[72:75] offset:256
  ds_write_b128 v14, v[76:79] offset:272
  s_mov_b64 exec, -1
  v_cvt_pk_bf16_f32 v80, v128, v129
  v_cvt_pk_bf16_f32 v81, v130, v131
  v_cvt_pk_bf16_f32 v82, v132, v133
  v_cvt_pk_bf16_f32 v83, v134, v135
  v_cvt_pk_bf16_f32 v84, v136, v137
  v_cvt_pk_bf16_f32 v85, v138, v139
  v_cvt_pk_bf16_f32 v86, v140, v141
  v_cvt_pk_bf16_f32 v87, v142, v143
  s_mov_b64 exec, s[70:71]
  ds_write_b128 v14, v[80:83] offset:512
  ds_write_b128 v14, v[84:87] offset:528
  s_mov_b64 exec, -1
  s_nop 4
  v_cvt_pk_bf16_f32 v88, v144, v145
  v_cvt_pk_bf16_f32 v89, v146, v147
  v_cvt_pk_bf16_f32 v90, v148, v149
  v_cvt_pk_bf16_f32 v91, v150, v151
  v_cvt_pk_bf16_f32 v92, v152, v153
  v_cvt_pk_bf16_f32 v93, v154, v155
  v_cvt_pk_bf16_f32 v94, v156, v157
  v_cvt_pk_bf16_f32 v95, v158, v159
  s_mov_b64 exec, s[70:71]
  ds_write_b128 v14, v[88:91] offset:768
  ds_write_b128 v14, v[92:95] offset:784
  s_mov_b64 exec, -1
  v_lshlrev_b32 v15, 4, v10
  s_mul_i32 s59, s36, 1040
  s_add_u32 s59, s59, s58
  v_add_u32 v16, s59, v15
  s_add_u32 s59, s3, s36
  s_lshl_b32 s59, s59, 10
  s_waitcnt lgkmcnt(0)
  s_barrier
  ds_read_b128 v[24:27], v16 offset:0
  ds_read_b128 v[28:31], v16 offset:4160
  ds_read_b128 v[32:35], v16 offset:8320
  ds_read_b128 v[36:39], v16 offset:12480
  ds_read_b128 v[40:43], v16 offset:16640
  ds_read_b128 v[44:47], v16 offset:20800
  ds_read_b128 v[48:51], v16 offset:24960
  s_add_u32 s52, s36, 0
  s_cmp_ge_u32 s52, s11
  s_cbranch_scc1 K2_FIN
  s_waitcnt lgkmcnt(6)
  s_add_u32 s61, s59, 0
  buffer_store_dwordx4 v[24:27], v15, s[64:67], s61 offen sc1
  s_add_u32 s52, s36, 4
  s_cmp_ge_u32 s52, s11
  s_cbranch_scc1 K2_FIN
  s_waitcnt lgkmcnt(5)
  s_add_u32 s61, s59, 4096
  buffer_store_dwordx4 v[28:31], v15, s[64:67], s61 offen sc1
  s_add_u32 s52, s36, 8
  s_cmp_ge_u32 s52, s11
  s_cbranch_scc1 K2_FIN
  s_waitcnt lgkmcnt(4)
  s_add_u32 s61, s59, 8192
  buffer_store_dwordx4 v[32:35], v15, s[64:67], s61 offen sc1
  s_add_u32 s52, s36, 12
  s_cmp_ge_u32 s52, s11
  s_cbranch_scc1 K2_FIN
  s_waitcnt lgkmcnt(3)
  s_add_u32 s61, s59, 12288
  buffer_store_dwordx4 v[36:39], v15, s[64:67], s61 offen sc1
  s_add_u32 s52, s36, 16
  s_cmp_ge_u32 s52, s11
  s_cbranch_scc1 K2_FIN
  s_waitcnt lgkmcnt(2)
  s_add_u32 s61, s59, 16384
  buffer_store_dwordx4 v[40:43], v15, s[64:67], s61 offen sc1
  s_add_u32 s52, s36, 20
  s_cmp_ge_u32 s52, s11
  s_cbranch_scc1 K2_FIN
  s_waitcnt lgkmcnt(1)
  s_add_u32 s61, s59, 20480
  buffer_store_dwordx4 v[44:47], v15, s[64:67], s61 offen sc1
  s_add_u32 s52, s36, 24
  s_cmp_ge_u32 s52, s11
  s_cbranch_scc1 K2_FIN
  s_waitcnt lgkmcnt(0)
  s_add_u32 s61, s59, 24576
  buffer_store_dwordx4 v[48:51], v15, s[64:67], s61 offen sc1
K2_FIN:
K2_END:
  s_endpgm
K2_PB0:
  s_mov_b32 s28, s6
  s_mov_b32 s29, s7
  s_mov_b32 s30, 75000
  s_mov_b32 s31, 0x20000
  s_cmp_lg_u32 s32, 7
  s_cbranch_scc1 K2_NOPF
  s_lshr_b32 s56, s2, 3
  s_mul_i32 s56, s56, 2432
  v_lshlrev_b32 v13, 7, v10
  s_mov_b64 exec, 0x7ffff
  buffer_load_dword v95, v13, s[28:31], s56 offen
  s_mov_b64 exec, -1
K2_NOPF:
  s_mul_i32 s56, s36, 24576
  s_lshl_b32 s58, s36, 14
  s_add_u32 s57, s56, 3211264
  s_add_u32 m0, s58, 97088
  s_nop 0
  buffer_load_dwordx4 v9, s[24:27], s57 offen offset:0 lds
  buffer_load_dwordx4 v9, s[24:27], s57 offen offset:1024 lds
  buffer_load_dwordx4 v9, s[24:27], s57 offen offset:2048 lds
  buffer_load_dwordx4 v9, s[24:27], s57 offen offset:3072 lds
  s_add_u32 s57, s56, 3215360
  s_add_u32 m0, s58, 101184
  s_nop 0
  buffer_load_dwordx4 v9, s[24:27], s57 offen offset:0 lds
  buffer_load_dwordx4 v9, s[24:27], s57 offen offset:1024 lds
  buffer_load_dwordx4 v9, s[24:27], s57 offen offset:2048 lds
  buffer_load_dwordx4 v9, s[24:27], s57 offen offset:3072 lds
  s_branch K2_COMMON
K2_PB2:
  s_mul_i32 s56, s36, 24576
  s_lshl_b32 s58, s36, 14
  s_add_u32 s57, s56, 3219456
  s_add_u32 m0, s58, 105280
  s_nop 0
  buffer_load_dwordx4 v9, s[24:27], s57 offen offset:0 lds
  buffer_load_dwordx4 v9, s[24:27], s57 offen offset:1024 lds
  buffer_load_dwordx4 v9, s[24:27], s57 offen offset:2048 lds
  buffer_load_dwordx4 v9, s[24:27], s57 offen offset:3072 lds
  s_add_u32 s57, s56, 3223552
  s_add_u32 m0, s58, 109376
  s_nop 0
  buffer_load_dwordx4 v9, s[24:27], s57 offen offset:0 lds
  buffer_load_dwordx4 v9, s[24:27], s57 offen offset:1024 lds
  buffer_load_dwordx4 v9, s[24:27], s57 offen offset:2048 lds
  buffer_load_dwordx4 v9, s[24:27], s57 offen offset:3072 lds
  s_branch K2_SCAN
K2_PA_R:
  v_and_b32 v10, 63, v0
  v_lshlrev_b32 v10, 4, v10
  s_lshl_b32 s57, s36, 6
  v_xor_b32 v10, s57, v10
  s_add_u32 s57, s3, s36
  s_lshl_b32 s57, s57, 10
  s_lshl_b32 s58, s36, 10
  s_add_u32 s56, s59, s58
  s_add_u32 s52, s36, 0
  s_add_u32 s58, s57, 0
  s_cmp_lt_u32 s52, s11
  s_cselect_b32 s58, s58, 0x7f000000
  s_add_u32 m0, s56, 0
  s_nop 0
  buffer_load_dwordx4 v10, s[16:19], s58 offen lds
  s_add_u32 s52, s36, 4
  s_add_u32 s58, s57, 4096
  s_cmp_lt_u32 s52, s11
  s_cselect_b32 s58, s58, 0x7f000000
  s_add_u32 m0, s56, 4096
  s_nop 0
  buffer_load_dwordx4 v10, s[16:19], s58 offen lds
  s_add_u32 s52, s36, 8
  s_add_u32 s58, s57, 8192
  s_cmp_lt_u32 s52, s11
  s_cselect_b32 s58, s58, 0x7f000000
  s_add_u32 m0, s56, 8192
  s_nop 0
  buffer_load_dwordx4 v10, s[16:19], s58 offen lds
  s_add_u32 s52, s36, 12
  s_add_u32 s58, s57, 12288
  s_cmp_lt_u32 s52, s11
  s_cselect_b32 s58, s58, 0x7f000000
  s_add_u32 m0, s56, 12288
  s_nop 0
  buffer_load_dwordx4 v10, s[16:19], s58 offen lds
  s_add_u32 s52, s36, 16
  s_add_u32 s58, s57, 16384
  s_cmp_lt_u32 s52, s11
  s_cselect_b32 s58, s58, 0x7f000000
  s_add_u32 m0, s56, 16384
  s_nop 0
  buffer_load_dwordx4 v10, s[16:19], s58 offen lds
  s_add_u32 s52, s36, 20
  s_add_u32 s58, s57, 20480
  s_cmp_lt_u32 s52, s11
  s_cselect_b32 s58, s58, 0x7f000000
  s_add_u32 m0, s56, 20480
  s_nop 0
  buffer_load_dwordx4 v10, s[16:19], s58 offen lds
  s_add_u32 s52, s36, 24
  s_add_u32 s58, s57, 24576
  s_cmp_lt_u32 s52, s11
  s_cselect_b32 s58, s58, 0x7f000000
  s_add_u32 m0, s56, 24576
  s_nop 0
  buffer_load_dwordx4 v10, s[16:19], s58 offen lds
  s_add_u32 s52, s36, 28
  s_add_u32 s58, s57, 28672
  s_cmp_lt_u32 s52, s11
  s_cselect_b32 s58, s58, 0x7f000000
  s_add_u32 m0, s56, 28672
  s_nop 0
  buffer_load_dwordx4 v10, s[16:19], s58 offen lds
  ds_read_b64 v[22:23], v4
  ds_read_b128 v[24:27], v1
  ds_read_b128 v[28:31], v1 offset:32
  s_waitcnt lgkmcnt(0)
  v_mfma_f32_32x32x8_bf16 v[32:47], v[22:23], v[16:17], 0
  v_mfma_f32_32x32x16_bf16 v[48:63], v[24:27], v[160:163], 0
  v_mfma_f32_32x32x16_bf16 v[64:79], v[24:27], v[192:195], 0
  v_mfma_f32_32x32x16_bf16 v[80:95], v[24:27], v[224:227], 0
  ds_read_b128 v[24:27], v1 offset:64
  s_waitcnt lgkmcnt(1)
  v_mfma_f32_32x32x16_bf16 v[48:63], v[28:31], v[164:167], v[48:63]
  v_mfma_f32_32x32x16_bf16 v[64:79], v[28:31], v[196:199], v[64:79]
  v_mfma_f32_32x32x16_bf16 v[80:95], v[28:31], v[228:231], v[80:95]
  ds_read_b128 v[28:31], v1 offset:96
  s_waitcnt lgkmcnt(1)
  v_mfma_f32_32x32x16_bf16 v[48:63], v[24:27], v[168:171], v[48:63]
  v_mfma_f32_32x32x16_bf16 v[64:79], v[24:27], v[200:203], v[64:79]
  v_mfma_f32_32x32x16_bf16 v[80:95], v[24:27], v[232:235], v[80:95]
  ds_read_b128 v[24:27], v1 offset:128
  s_waitcnt lgkmcnt(1)
  v_mfma_f32_32x32x16_bf16 v[48:63], v[28:31], v[172:175], v[48:63]
  v_mfma_f32_32x32x16_bf16 v[64:79], v[28:31], v[204:207], v[64:79]
  v_mfma_f32_32x32x16_bf16 v[80:95], v[28:31], v[236:239], v[80:95]
  ds_read_b128 v[28:31], v1 offset:160
  s_waitcnt lgkmcnt(1)
  v_mfma_f32_32x32x16_bf16 v[48:63], v[24:27], v[176:179], v[48:63]
  v_mfma_f32_32x32x16_bf16 v[64:79], v[24:27], v[208:211], v[64:79]
  v_mfma_f32_32x32x16_bf16 v[80:95], v[24:27], v[240:243], v[80:95]
  ds_read_b128 v[24:27], v1 offset:192
  s_waitcnt lgkmcnt(1)
  v_mfma_f32_32x32x16_bf16 v[48:63], v[28:31], v[180:183], v[48:63]
  v_mfma_f32_32x32x16_bf16 v[64:79], v[28:31], v[212:215], v[64:79]
  v_mfma_f32_32x32x16_bf16 v[80:95], v[28:31], v[244:247], v[80:95]
  ds_read_b128 v[28:31], v1 offset:224
  s_waitcnt lgkmcnt(1)
  v_mfma_f32_32x32x16_bf16 v[48:63], v[24:27], v[184:187], v[48:63]
  v_mfma_f32_32x32x16_bf16 v[64:79], v[24:27], v[216:219], v[64:79]
  v_mfma_f32_32x32x16_bf16 v[80:95], v[24:27], v[248:251], v[80:95]
  s_waitcnt lgkmcnt(0)
  v_mfma_f32_32x32x16_bf16 v[48:63], v[28:31], v[188:191], v[48:63]
  v_mfma_f32_32x32x16_bf16 v[64:79], v[28:31], v[220:223], v[64:79]
  v_mfma_f32_32x32x16_bf16 v[80:95], v[28:31], v[252:255], v[80:95]
  s_branch K2_MID
K2_NOW2B:
  v_and_b32 v10, 63, v0
  v_lshlrev_b32 v10, 4, v10
  s_lshl_b32 s56, s36, 14
  s_add_u32 s56, s56, 97088
  v_add_u32 v10, s56, v10
  ds_read_b128 v[160:163], v10 offset:0
  ds_read_b128 v[164:167], v10 offset:1024
  ds_read_b128 v[168:171], v10 offset:2048
  ds_read_b128 v[172:175], v10 offset:3072
  ds_read_b128 v[176:179], v10 offset:4096
  ds_read_b128 v[180:183], v10 offset:5120
  ds_read_b128 v[184:187], v10 offset:6144
  ds_read_b128 v[188:191], v10 offset:7168
  ds_read_b128 v[192:195], v10 offset:8192
  ds_read_b128 v[196:199], v10 offset:9216
  ds_read_b128 v[200:203], v10 offset:10240
  ds_read_b128 v[204:207], v10 offset:11264
  ds_read_b128 v[208:211], v10 offset:12288
  ds_read_b128 v[212:215], v10 offset:13312
  ds_read_b128 v[216:219], v10 offset:14336
  ds_read_b128 v[220:223], v10 offset:15360
K2_NOW2:
  s_mov_b32 s59, s14
  s_cmp_eq_u32 s37, 0
  s_cbranch_scc1 K2_I0Ra
  ds_read_b64 v[66:67], v6
  s_mul_i32 s57, s36, 2112
  s_add_u32 s57, s57, s59
  s_mul_i32 s58, s36, 6144
  s_add_u32 s58, s58, s59
  s_add_u32 s58, s58, 8448
  s_waitcnt lgkmcnt(0)
  v_and_b32 v66, s60, v66
  v_and_b32 v67, s60, v67
  v_lshl_add_u32 v68, v66, 8, v7
  v_lshl_add_u32 v69, v67, 8, v7
  v_lshl_add_u32 v70, v66, 10, v8
  v_lshl_add_u32 v71, v67, 10, v8
  v_xor_b32 v71, 64, v71
  v_add_u32 v6, s9, v6
  s_mov_b32 m0, s57
  s_nop 0
  buffer_load_dwordx4 v68, s[20:23], 0 offen  lds
  s_add_u32 m0, s57, 1056
  s_nop 0
  buffer_load_dwordx4 v69, s[20:23], 0 offen  lds
  s_add_u32 m0, s58, 0
  s_nop 0
  buffer_load_dwordx4 v70, s[16:19], s42 offen  lds
  s_add_u32 m0, s58, 1024
  s_nop 0
  buffer_load_dwordx4 v70, s[16:19], s43 offen  lds
  s_add_u32 m0, s58, 2048
  s_nop 0
  buffer_load_dwordx4 v70, s[16:19], s44 offen  lds
  s_add_u32 m0, s58, 3072
  s_nop 0
  buffer_load_dwordx4 v71, s[16:19], s42 offen  lds
  s_add_u32 m0, s58, 4096
  s_nop 0
  buffer_load_dwordx4 v71, s[16:19], s43 offen  lds
  s_add_u32 m0, s58, 5120
  s_nop 0
  buffer_load_dwordx4 v71, s[16:19], s44 offen  lds
K2_I0Da:
  s_branch K2_I0DONE
K2_I0Ra:
  s_cmp_eq_u32 s53, 0
  s_cbranch_scc1 K2_I0Ga
  v_and_b32 v10, 63, v0
  v_lshlrev_b32 v10, 4, v10
  s_lshl_b32 s57, s36, 6
  v_xor_b32 v10, s57, v10
  s_add_u32 s57, s3, s36
  s_lshl_b32 s57, s57, 10
  s_lshl_b32 s58, s36, 10
  s_add_u32 s56, s59, s58
  s_add_u32 s52, s36, 0
  s_add_u32 s58, s57, 0
  s_cmp_lt_u32 s52, s11
  s_cselect_b32 s58, s58, 0x7f000000
  s_add_u32 m0, s56, 0
  s_nop 0
  buffer_load_dwordx4 v10, s[16:19], s58 offen lds
  s_add_u32 s52, s36, 4
  s_add_u32 s58, s57, 4096
  s_cmp_lt_u32 s52, s11
  s_cselect_b32 s58, s58, 0x7f000000
  s_add_u32 m0, s56, 4096
  s_nop 0
  buffer_load_dwordx4 v10, s[16:19], s58 offen lds
  s_add_u32 s52, s36, 8
  s_add_u32 s58, s57, 8192
  s_cmp_lt_u32 s52, s11
  s_cselect_b32 s58, s58, 0x7f000000
  s_add_u32 m0, s56, 8192
  s_nop 0
  buffer_load_dwordx4 v10, s[16:19], s58 offen lds
  s_add_u32 s52, s36, 12
  s_add_u32 s58, s57, 12288
  s_cmp_lt_u32 s52, s11
  s_cselect_b32 s58, s58, 0x7f000000
  s_add_u32 m0, s56, 12288
  s_nop 0
  buffer_load_dwordx4 v10, s[16:19], s58 offen lds
  s_add_u32 s52, s36, 16
  s_add_u32 s58, s57, 16384
  s_cmp_lt_u32 s52, s11
  s_cselect_b32 s58, s58, 0x7f000000
  s_add_u32 m0, s56, 16384
  s_nop 0
  buffer_load_dwordx4 v10, s[16:19], s58 offen lds
  s_add_u32 s52, s36, 20
  s_add_u32 s58, s57, 20480
  s_cmp_lt_u32 s52, s11
  s_cselect_b32 s58, s58, 0x7f000000
  s_add_u32 m0, s56, 20480
  s_nop 0
  buffer_load_dwordx4 v10, s[16:19], s58 offen lds
  s_add_u32 s52, s36, 24
  s_add_u32 s58, s57, 24576
  s_cmp_lt_u32 s52, s11
  s_cselect_b32 s58, s58, 0x7f000000
  s_add_u32 m0, s56, 24576
  s_nop 0
  buffer_load_dwordx4 v10, s[16:19], s58 offen lds
  s_add_u32 s52, s36, 28
  s_add_u32 s58, s57, 28672
  s_cmp_lt_u32 s52, s11
  s_cselect_b32 s58, s58, 0x7f000000
  s_add_u32 m0, s56, 28672
  s_nop 0
  buffer_load_dwordx4 v10, s[16:19], s58 offen lds
  s_branch K2_I0Da
K2_I0Ga:
  ds_read_b64 v[66:67], v6
  s_mul_i32 s57, s36, 2112
  s_add_u32 s57, s57, s59
  s_mul_i32 s58, s36, 6144
  s_add_u32 s58, s58, s59
  s_add_u32 s58, s58, 8448
  s_waitcnt lgkmcnt(0)
  v_and_b32 v66, s60, v66
  v_and_b32 v67, s60, v67
  v_lshl_add_u32 v68, v66, 8, v7
  v_lshl_add_u32 v69, v67, 8, v7
  v_lshl_add_u32 v70, v66, 10, v8
  v_lshl_add_u32 v71, v67, 10, v8
  v_xor_b32 v71, 64, v71
  v_add_u32 v6, s9, v6
  s_mov_b32 m0, s57
  s_nop 0
  buffer_load_dwordx4 v68, s[20:23], 0 offen  lds
  s_add_u32 m0, s57, 1056
  s_nop 0
  buffer_load_dwordx4 v69, s[20:23], 0 offen  lds
  s_add_u32 m0, s58, 0
  s_nop 0
  buffer_load_dwordx4 v70, s[16:19], s42 offen  lds
  s_add_u32 m0, s58, 1024
  s_nop 0
  buffer_load_dwordx4 v70, s[16:19], s43 offen  lds
  s_add_u32 m0, s58, 2048
  s_nop 0
  buffer_load_dwordx4 v70, s[16:19], s44 offen  lds
  s_add_u32 m0, s58, 3072
  s_nop 0
  buffer_load_dwordx4 v71, s[16:19], s42 offen  lds
  s_add_u32 m0, s58, 4096
  s_nop 0
  buffer_load_dwordx4 v71, s[16:19], s43 offen  lds
  s_add_u32 m0, s58, 5120
  s_nop 0
  buffer_load_dwordx4 v71, s[16:19], s44 offen  lds
  s_branch K2_I0Da
K2_RARE1:
  s_cmp_eq_u64 s[0:1], 0
  s_cbranch_scc1 K2_NOFLAG
  v_mov_b32 v66, 30496
  ds_write_b32 v66, v35
K2_NOFLAG:
  v_cmp_lt_u32 vcc, 3, v56
  s_andn2_b64 exec, vcc, s[68:69]
  v_lshrrev_b32 v66, 14, v47
  v_lshlrev_b32 v66, 3, v66
  ds_add_rtn_u32 v79, v66, v35 offset:29952
  s_mov_b64 exec, -1
  v_cmp_lt_u32 vcc, 3, v57
  s_andn2_b64 exec, vcc, s[70:71]
  v_lshrrev_b32 v66, 14, v53
  v_lshlrev_b32 v66, 3, v66
  ds_add_rtn_u32 v85, v66, v35 offset:29952
  s_mov_b64 exec, -1
  v_cmp_lt_u32 vcc, 4, v56
  s_andn2_b64 exec, vcc, s[68:69]
  v_lshrrev_b32 v66, 14, v48
  v_lshlrev_b32 v66, 3, v66
  ds_add_rtn_u32 v80, v66, v35 offset:29952
  s_mov_b64 exec, -1
  v_cmp_lt_u32 vcc, 4, v57
  s_andn2_b64 exec, vcc, s[70:71]
  v_lshrrev_b32 v66, 14, v54
  v_lshlrev_b32 v66, 3, v66
  ds_add_rtn_u32 v86, v66, v35 offset:29952
  s_mov_b64 exec, -1
  v_cmp_lt_u32 vcc, 5, v56
  s_andn2_b64 exec, vcc, s[68:69]
  v_lshrrev_b32 v66, 14, v49
  v_lshlrev_b32 v66, 3, v66
  ds_add_rtn_u32 v81, v66, v35 offset:29952
  s_mov_b64 exec, -1
  v_cmp_lt_u32 vcc, 5, v57
  s_andn2_b64 exec, vcc, s[70:71]
  v_lshrrev_b32 v66, 14, v55
  v_lshlrev_b32 v66, 3, v66
  ds_add_rtn_u32 v87, v66, v35 offset:29952
  s_mov_b64 exec, -1
  s_branch K2_RARE1_RET
K2_RARE2:
  v_cmp_lt_u32 vcc, 3, v56
  s_mov_b64 exec, vcc
  v_lshrrev_b32 v74, 14, v47
  v_lshlrev_b32 v74, 3, v74
  ds_read_b64 v[72:73], v74 offset:30528
  s_waitcnt lgkmcnt(0)
  v_mad_i32_i24 v74, v79, v73, v72
  ds_write_b32 v74, v47
  s_mov_b64 exec, -1
  v_cmp_lt_u32 vcc, 3, v57
  s_mov_b64 exec, vcc
  v_lshrrev_b32 v74, 14, v53
  v_lshlrev_b32 v74, 3, v74
  ds_read_b64 v[72:73], v74 offset:30528
  s_waitcnt lgkmcnt(0)
  v_mad_i32_i24 v74, v85, v73, v72
  ds_write_b32 v74, v53
  s_mov_b64 exec, -1
  v_cmp_lt_u32 vcc, 4, v56
  s_mov_b64 exec, vcc
  v_lshrrev_b32 v74, 14, v48
  v_lshlrev_b32 v74, 3, v74
  ds_read_b64 v[72:73], v74 offset:30528
  s_waitcnt lgkmcnt(0)
  v_mad_i32_i24 v74, v80, v73, v72
  ds_write_b32 v74, v48
  s_mov_b64 exec, -1
  v_cmp_lt_u32 vcc, 4, v57
  s_mov_b64 exec, vcc
  v_lshrrev_b32 v74, 14, v54
  v_lshlrev_b32 v74, 3, v74
  ds_read_b64 v[72:73], v74 offset:30528
  s_waitcnt lgkmcnt(0)
  v_mad_i32_i24 v74, v86, v73, v72
  ds_write_b32 v74, v54
  s_mov_b64 exec, -1
  v_cmp_lt_u32 vcc, 5, v56
  s_mov_b64 exec, vcc
  v_lshrrev_b32 v74, 14, v49
  v_lshlrev_b32 v74, 3, v74
  ds_read_b64 v[72:73], v74 offset:30528
  s_waitcnt lgkmcnt(0)
  v_mad_i32_i24 v74, v81, v73, v72
  ds_write_b32 v74, v49
  s_mov_b64 exec, -1
  v_cmp_lt_u32 vcc, 5, v57
  s_mov_b64 exec, vcc
  v_lshrrev_b32 v74, 14, v55
  v_lshlrev_b32 v74, 3, v74
  ds_read_b64 v[72:73], v74 offset:30528
  s_waitcnt lgkmcnt(0)
  v_mad_i32_i24 v74, v87, v73, v72
  ds_write_b32 v74, v55
  s_mov_b64 exec, -1
  s_branch K2_FASTB
K2_PAD:
  s_cmp_ge_u32 s35, s39
  s_cbranch_scc1 K2_PADEND
  s_barrier
  s_add_u32 s35, s35, 1
  s_branch K2_PAD
K2_PADEND:
  s_add_u32 s40, s40, 192
  s_waitcnt vmcnt(0) lgkmcnt(0)
  s_barrier
  v_mov_b32 v24, 0
  v_mov_b32 v25, 0
  v_mov_b32 v26, 0
  v_mov_b32 v27, 0
  s_lshl_b32 s52, s33, 8
  v_add_u32 v29, s52, v0
  v_lshlrev_b32 v28, 4, v29
  ds_write_b128 v28, v[24:27] offset:0
  ds_write_b128 v28, v[24:27] offset:8192
  ds_write_b128 v28, v[24:27] offset:16384
  v_cmp_gt_u32 vcc, 240, v29
  s_mov_b64 exec, vcc
  ds_write_b128 v28, v[24:27] offset:24576
  s_mov_b64 exec, -1
  v_cmp_gt_u32 vcc, 36, v29
  s_mov_b64 exec, vcc
  ds_write_b128 v28, v[24:27] offset:29952
  s_mov_b64 exec, -1
  v_mov_b32 v30, 0x3fff
  v_lshlrev_b32 v28, 2, v29
  v_cmp_gt_u32 vcc, 384, v29
  s_mov_b64 exec, vcc
  ds_write_b32 v28, v30 offset:28416
  s_mov_b64 exec, -1
  v_and_b32 v10, 63, v0
  v_and_b32 v11, 31, v10
  v_lshrrev_b32 v12, 5, v10
  v_and_b32 v13, 7, v11
  v_mul_u32_u24 v1, 1056, v13
  v_lshrrev_b32 v13, 3, v11
  v_lshl_add_u32 v1, v13, 8, v1
  v_and_b32 v13, 1, v13
  v_xor_b32 v13, v13, v12
  v_lshl_add_u32 v1, v13, 4, v1
  v_add_u32 v1, s14, v1
  v_bfe_u32 v13, v10, 2, 2
  v_lshl_add_u32 v14, v12, 2, v13
  v_mul_u32_u24 v2, 3072, v14
  v_xor_b32 v13, s36, v13
  v_lshl_add_u32 v2, v13, 6, v2
  v_and_b32 v13, 1, v10
  v_lshl_add_u32 v2, v13, 5, v2
  v_bfe_u32 v13, v10, 4, 1
  v_lshl_add_u32 v2, v13, 4, v2
  v_bfe_u32 v13, v10, 1, 1
  v_lshl_add_u32 v2, v13, 3, v2
  s_add_u32 s52, s14, 8448
  v_add_u32 v2, s52, v2
  v_lshrrev_b32 v13, 4, v10
  v_and_b32 v14, 15, v10
  v_and_b32 v15, 1, v13
  v_xor_b32 v15, v15, v14
  v_lshlrev_b32 v7, 4, v15
  s_lshl_b32 s52, s36, 1
  s_and_b32 s52, s52, 3
  v_lshrrev_b32 v15, 2, v14
  v_xor_b32 v15, s52, v15
  v_lshlrev_b32 v15, 2, v15
  v_and_b32 v13, 3, v14
  v_add_u32 v15, v15, v13
  v_lshlrev_b32 v8, 4, v15
  s_cmp_lg_u32 s33, 0
  s_cbranch_scc1 K2_RB
  v_lshlrev_b32 v33, 13, v0
  v_mov_b32 v36, 0
  v_mov_b32 v37, 0
  v_mov_b32 v38, 0
  v_mov_b32 v39, 0
  v_mov_b32 v40, 0
  v_mov_b32 v41, 0
  v_mov_b32 v42, 0
  v_mov_b32 v43, 0
  s_mov_b64 exec, s[62:63]
  buffer_load_dwordx4 v[36:39], v33, s[24:27], s13 offen
  buffer_load_dwordx4 v[40:43], v33, s[24:27], s13 offen offset:16
  s_mov_b64 exec, -1
  s_waitcnt vmcnt(0)
  v_and_b32 v44, s61, v36
  v_alignbit_b32 v45, v37, v36, 19
  v_lshrrev_b32 v46, 6, v37
  v_alignbit_b32 v47, v38, v37, 25
  v_lshrrev_b32 v48, 12, v38
  v_alignbit_b32 v49, v39, v38, 31
  v_and_b32 v45, s61, v45
  v_and_b32 v46, s61, v46
  v_and_b32 v47, s61, v47
  v_and_b32 v48, s61, v48
  v_and_b32 v49, s61, v49
  v_lshrrev_b32 v60, 18, v39
  v_and_b32 v56, 7, v60
  v_lshrrev_b32 v60, 3, v60
  v_cmp_eq_u32 vcc, 7, v56
  s_mov_b64 s[68:69], vcc
  v_and_b32 v50, s61, v40
  v_alignbit_b32 v51, v41, v40, 19
  v_lshrrev_b32 v52, 6, v41
  v_alignbit_b32 v53, v42, v41, 25
  v_lshrrev_b32 v54, 12, v42
  v_alignbit_b32 v55, v43, v42, 31
  v_and_b32 v51, s61, v51
  v_and_b32 v52, s61, v52
  v_and_b32 v53, s61, v53
  v_and_b32 v54, s61, v54
  v_and_b32 v55, s61, v55
  v_add_u32 v50, 409600, v50
  v_add_u32 v51, 409600, v51
  v_add_u32 v52, 409600, v52
  v_add_u32 v53, 409600, v53
  v_add_u32 v54, 409600, v54
  v_add_u32 v55, 409600, v55
  v_lshrrev_b32 v61, 18, v43
  v_and_b32 v57, 7, v61
  v_lshrrev_b32 v61, 3, v61
  v_cmp_eq_u32 vcc, 7, v57
  s_mov_b64 s[70:71], vcc
K2_RB:
  s_waitcnt vmcnt(0) lgkmcnt(0)
  s_barrier
  s_branch K2_SLOWR
K2_SLOW:
  s_movk_i32 s12, 25
  s_cmp_lg_u32 s33, 0
  s_cbranch_scc1 K2_SLOWB
  s_branch K2_SLOWA
K2_SLOWR:
  s_movk_i32 s12, 25
  s_cmp_lg_u32 s33, 0
  s_cbranch_scc1 K2_SLOWB
K2_SLOWA:
  v_mov_b32 v58, v56
  s_cmp_eq_u64 s[68:69], 0
  s_cbranch_scc1 K2_NOOVF1_0
  v_mul_u32_u24 v64, 8192, v0
  v_lshl_add_u32 v64, v60, 2, v64
  s_mov_b32 s52, 5505024
  s_mov_b64 exec, s[68:69]
  buffer_load_dword v56, v64, s[24:27], s52 offen
  v_mov_b32 v58, 0
  s_waitcnt vmcnt(0)
  v_min_u32 v56, 1600, v56
  s_mov_b64 exec, -1
K2_NOOVF1_0:
  v_mov_b32 v59, v57
  s_cmp_eq_u64 s[70:71], 0
  s_cbranch_scc1 K2_NOOVF1_1
  v_mul_u32_u24 v65, 8192, v0
  v_lshl_add_u32 v65, v61, 2, v65
  s_mov_b32 s52, 5505024
  s_mov_b64 exec, s[70:71]
  buffer_load_dword v57, v65, s[24:27], s52 offen
  v_mov_b32 v59, 0
  s_waitcnt vmcnt(0)
  v_min_u32 v57, 1600, v57
  s_mov_b64 exec, -1
K2_NOOVF1_1:
  v_mov_b32 v62, v56
  v_mov_b32 v63, v57
  s_nop 0
  v_add_u32_dpp v62, v62, v62 row_shr:1 row_mask:0xf bank_mask:0xf bound_ctrl:0
  v_add_u32_dpp v63, v63, v63 row_shr:1 row_mask:0xf bank_mask:0xf bound_ctrl:0
  s_nop 0
  v_add_u32_dpp v62, v62, v62 row_shr:2 row_mask:0xf bank_mask:0xf bound_ctrl:0
  v_add_u32_dpp v63, v63, v63 row_shr:2 row_mask:0xf bank_mask:0xf bound_ctrl:0
  s_nop 0
  v_add_u32_dpp v62, v62, v62 row_shr:4 row_mask:0xf bank_mask:0xf bound_ctrl:0
  v_add_u32_dpp v63, v63, v63 row_shr:4 row_mask:0xf bank_mask:0xf bound_ctrl:0
  s_nop 0
  v_add_u32_dpp v62, v62, v62 row_shr:8 row_mask:0xf bank_mask:0xf bound_ctrl:0
  v_add_u32_dpp v63, v63, v63 row_shr:8 row_mask:0xf bank_mask:0xf bound_ctrl:0
  s_nop 0
  v_add_u32_dpp v62, v62, v62 row_bcast:15 row_mask:0xa bank_mask:0xf
  v_add_u32_dpp v63, v63, v63 row_bcast:15 row_mask:0xa bank_mask:0xf
  s_nop 0
  v_add_u32_dpp v62, v62, v62 row_bcast:31 row_mask:0xc bank_mask:0xf
  v_add_u32_dpp v63, v63, v63 row_bcast:31 row_mask:0xc bank_mask:0xf
  s_nop 0
  v_readlane_b32 s52, v62, 63
  v_readlane_b32 s56, v63, 63
  v_sub_u32 v62, v62, v56
  v_sub_u32 v63, v63, v57
  s_lshl_b32 s57, s36, 2
  s_add_u32 s57, s57, 30464
  v_mov_b32 v66, s57
  v_mov_b32 v67, s52
  v_mov_b32 v68, s56
  ds_write_b32 v66, v67
  ds_write_b32 v66, v68 offset:16
K2_SLOWB:
  s_waitcnt lgkmcnt(0)
  s_barrier
K2_SLOWB2:
  v_mov_b32 v66, 30464
  ds_read_b128 v[68:71], v66
  ds_read_b128 v[72:75], v66 offset:16
  s_waitcnt lgkmcnt(0)
  v_readfirstlane_b32 s6, v68
  v_readfirstlane_b32 s7, v69
  v_readfirstlane_b32 s10, v70
  v_readfirstlane_b32 s11, v71
  v_readfirstlane_b32 s56, v72
  v_readfirstlane_b32 s57, v73
  v_readfirstlane_b32 s58, v74
  v_readfirstlane_b32 s59, v75
  s_nop 3
  s_cmp_gt_u32 s36, 0
  s_cselect_b32 s0, s6, 0
  s_cselect_b32 s1, s56, 0
  s_cmp_gt_u32 s36, 1
  s_cselect_b32 s8, s7, 0
  s_cselect_b32 s9, s57, 0
  s_add_u32 s0, s0, s8
  s_add_u32 s1, s1, s9
  s_cmp_gt_u32 s36, 2
  s_cselect_b32 s8, s10, 0
  s_cselect_b32 s9, s58, 0
  s_add_u32 s0, s0, s8
  s_add_u32 s1, s1, s9
  s_add_u32 s8, s6, s7
  s_add_u32 s8, s8, s10
  s_add_u32 s8, s8, s11
  s_add_u32 s9, s56, s57
  s_add_u32 s9, s9, s58
  s_add_u32 s9, s9, s59
  s_sub_u32 s0, s0, s40
  s_sub_u32 s1, s1, s40
  v_add_u32 v62, s0, v62
  v_add_u32 v63, s1, v63
  s_sub_u32 s56, s8, s40
  s_cselect_b32 s56, 0, s56
  s_sub_u32 s57, s9, s40
  s_cselect_b32 s57, 0, s57
  s_max_u32 s58, s56, s57
  s_cmp_le_u32 s58, 192
  s_cselect_b32 s53, 1, 0
  s_min_u32 s56, s56, 192
  s_min_u32 s57, s57, 192
  s_add_u32 s58, s56, 31
  s_lshr_b32 s58, s58, 5
  s_add_u32 s59, s57, 31
  s_lshr_b32 s59, s59, 5
  s_mov_b32 s52, 0
  s_mov_b32 s0, s58
  s_mov_b32 s1, s59
  s_lshl_b32 s0, s0, 1
  s_lshl_b32 s1, s1, 1
  s_add_u32 s1, s1, 1
  s_max_u32 s39, s0, s1
  s_xor_b32 s52, s52, s33
  s_cmp_eq_u32 s52, 0
  s_cselect_b32 s45, s56, s57
  s_cselect_b32 s37, s58, s59
  s_cselect_b32 s10, 0, s12
  s_cselect_b32 s34, 0, 11
  s_cselect_b32 s46, 1, -1
  s_mul_i32 s6, s46, 1728
  s_mul_i32 s7, s46, 256
  s_mul_i32 s8, s46, 384
  s_mul_i32 s9, s46, 128
  s_sub_u32 s0, 50, s12
  s_cmp_eq_u32 s52, 0
  s_cselect_b32 s11, s12, s0
  s_add_u32 s3, s15, s10
  v_and_b32 v10, 63, v0
  v_and_b32 v11, 31, v10
  v_lshrrev_b32 v12, 5, v10
  v_mul_u32_u24 v13, 27, v12
  v_add_u32 v13, v13, v11
  s_mul_i32 s52, s34, 1728
  v_lshl_add_u32 v3, v13, 4, s52
  s_mul_i32 s52, s34, 256
  s_add_u32 s52, s52, 20736
  v_lshl_add_u32 v4, v11, 3, s52
  s_mul_i32 s52, s34, 384
  s_add_u32 s52, s52, 23808
  v_lshl_add_u32 v5, v12, 4, s52
  v_lshrrev_b32 v13, 4, v10
  s_mul_i32 s52, s34, 128
  s_add_u32 s52, s52, 28416
  s_lshl_b32 s56, s36, 3
  s_add_u32 s52, s52, s56
  v_lshl_add_u32 v6, v13, 5, s52
  s_cmp_lg_u32 s33, 0
  s_cbranch_scc1 K2_AFTLIST
  s_movk_i32 s58, 192
  v_add_u32 v66, 0, v62
  v_cmp_lt_u32 vcc, 0, v58
  v_cmp_gt_u32 s[0:1], s58, v66
  v_lshlrev_b32 v66, 2, v66
  s_and_b64 exec, vcc, s[0:1]
  ds_write_b32 v66, v44 offset:28416
  s_mov_b64 exec, -1
  v_add_u32 v66, 1, v62
  v_cmp_lt_u32 vcc, 1, v58
  v_cmp_gt_u32 s[0:1], s58, v66
  v_lshlrev_b32 v66, 2, v66
  s_and_b64 exec, vcc, s[0:1]
  ds_write_b32 v66, v45 offset:28416
  s_mov_b64 exec, -1
  v_add_u32 v66, 2, v62
  v_cmp_lt_u32 vcc, 2, v58
  v_cmp_gt_u32 s[0:1], s58, v66
  v_lshlrev_b32 v66, 2, v66
  s_and_b64 exec, vcc, s[0:1]
  ds_write_b32 v66, v46 offset:28416
  s_mov_b64 exec, -1
  v_add_u32 v66, 3, v62
  v_cmp_lt_u32 vcc, 3, v58
  v_cmp_gt_u32 s[0:1], s58, v66
  v_lshlrev_b32 v66, 2, v66
  s_and_b64 exec, vcc, s[0:1]
  ds_write_b32 v66, v47 offset:28416
  s_mov_b64 exec, -1
  v_add_u32 v66, 4, v62
  v_cmp_lt_u32 vcc, 4, v58
  v_cmp_gt_u32 s[0:1], s58, v66
  v_lshlrev_b32 v66, 2, v66
  s_and_b64 exec, vcc, s[0:1]
  ds_write_b32 v66, v48 offset:28416
  s_mov_b64 exec, -1
  v_add_u32 v66, 5, v62
  v_cmp_lt_u32 vcc, 5, v58
  v_cmp_gt_u32 s[0:1], s58, v66
  v_lshlrev_b32 v66, 2, v66
  s_and_b64 exec, vcc, s[0:1]
  ds_write_b32 v66, v49 offset:28416
  s_mov_b64 exec, -1
  s_cmp_eq_u64 s[68:69], 0
  s_cbranch_scc1 K2_NOOVF2_0
  v_sub_u32 v66, 0, v62
  v_max_i32 v66, 0, v66
K2_OVL0:
  v_add_u32 v67, v62, v66
  v_cmp_lt_u32 vcc, v66, v56
  v_cmp_gt_u32 s[0:1], s58, v67
  s_and_b64 vcc, vcc, s[0:1]
  s_and_b64 exec, vcc, s[68:69]
  s_cbranch_execz K2_OVLEND0
  v_add_u32 v68, 1, v66
  v_lshl_add_u32 v68, v68, 2, v64
  s_mov_b32 s52, 5505024
  buffer_load_dword v69, v68, s[24:27], s52 offen
  v_lshlrev_b32 v67, 2, v67
  s_waitcnt vmcnt(0)
  ds_write_b32 v67, v69 offset:28416
  v_add_u32 v66, 1, v66
  s_mov_b64 exec, -1
  s_branch K2_OVL0
K2_OVLEND0:
  s_mov_b64 exec, -1
K2_NOOVF2_0:
  v_mov_b32 v70, 1532
  v_add_u32 v66, 0, v63
  v_cmp_lt_u32 vcc, 0, v59
  v_cmp_gt_u32 s[0:1], s58, v66
  v_lshlrev_b32 v66, 2, v66
  v_sub_u32 v66, v70, v66
  s_and_b64 exec, vcc, s[0:1]
  ds_write_b32 v66, v50 offset:28416
  s_mov_b64 exec, -1
  v_add_u32 v66, 1, v63
  v_cmp_lt_u32 vcc, 1, v59
  v_cmp_gt_u32 s[0:1], s58, v66
  v_lshlrev_b32 v66, 2, v66
  v_sub_u32 v66, v70, v66
  s_and_b64 exec, vcc, s[0:1]
  ds_write_b32 v66, v51 offset:28416
  s_mov_b64 exec, -1
  v_add_u32 v66, 2, v63
  v_cmp_lt_u32 vcc, 2, v59
  v_cmp_gt_u32 s[0:1], s58, v66
  v_lshlrev_b32 v66, 2, v66
  v_sub_u32 v66, v70, v66
  s_and_b64 exec, vcc, s[0:1]
  ds_write_b32 v66, v52 offset:28416
  s_mov_b64 exec, -1
  v_add_u32 v66, 3, v63
  v_cmp_lt_u32 vcc, 3, v59
  v_cmp_gt_u32 s[0:1], s58, v66
  v_lshlrev_b32 v66, 2, v66
  v_sub_u32 v66, v70, v66
  s_and_b64 exec, vcc, s[0:1]
  ds_write_b32 v66, v53 offset:28416
  s_mov_b64 exec, -1
  v_add_u32 v66, 4, v63
  v_cmp_lt_u32 vcc, 4, v59
  v_cmp_gt_u32 s[0:1], s58, v66
  v_lshlrev_b32 v66, 2, v66
  v_sub_u32 v66, v70, v66
  s_and_b64 exec, vcc, s[0:1]
  ds_write_b32 v66, v54 offset:28416
  s_mov_b64 exec, -1
  v_add_u32 v66, 5, v63
  v_cmp_lt_u32 vcc, 5, v59
  v_cmp_gt_u32 s[0:1], s58, v66
  v_lshlrev_b32 v66, 2, v66
  v_sub_u32 v66, v70, v66
  s_and_b64 exec, vcc, s[0:1]
  ds_write_b32 v66, v55 offset:28416
  s_mov_b64 exec, -1
  s_cmp_eq_u64 s[70:71], 0
  s_cbranch_scc1 K2_NOOVF2_1
  v_sub_u32 v66, 0, v63
  v_max_i32 v66, 0, v66
K2_OVL1:
  v_add_u32 v67, v63, v66
  v_cmp_lt_u32 vcc, v66, v57
  v_cmp_gt_u32 s[0:1], s58, v67
  s_and_b64 vcc, vcc, s[0:1]
  s_and_b64 exec, vcc, s[70:71]
  s_cbranch_execz K2_OVLEND1
  v_add_u32 v68, 1, v66
  v_lshl_add_u32 v68, v68, 2, v65
  s_mov_b32 s52, 5505024
  buffer_load_dword v69, v68, s[24:27], s52 offen
  v_lshlrev_b32 v67, 2, v67
  v_sub_u32 v67, v70, v67
  s_waitcnt vmcnt(0)
  v_add_u32 v69, 409600, v69
  ds_write_b32 v67, v69 offset:28416
  v_add_u32 v66, 1, v66
  s_mov_b64 exec, -1
  s_branch K2_OVL1
K2_OVLEND1:
  s_mov_b64 exec, -1
K2_NOOVF2_1:
  s_branch K2_AFTLIST
K2_CODE_END:
.section .rodata,"a"
.p2align 6
.amdhsa_kernel k1_kernel
  .amdhsa_next_free_vgpr 184
  .amdhsa_next_free_sgpr 96
  .amdhsa_accum_offset 184
  .amdhsa_group_segment_fixed_size 0
  .amdhsa_kernarg_size 88
  .amdhsa_user_sgpr_count 2
  .amdhsa_user_sgpr_kernarg_segment_ptr 1
  .amdhsa_system_sgpr_workgroup_id_x 1
.end_amdhsa_kernel
.p2align 6
.amdhsa_kernel k2_kernel
  .amdhsa_next_free_vgpr 256
  .amdhsa_next_free_sgpr 96
  .amdhsa_accum_offset 256
  .amdhsa_group_segment_fixed_size 0
  .amdhsa_kernarg_size 88
  .amdhsa_user_sgpr_count 2
  .amdhsa_user_sgpr_kernarg_segment_ptr 1
  .amdhsa_system_sgpr_workgroup_id_x 1
.end_amdhsa_kernel
```
